```python
import torch

def _softmax(x, axis=-1):
    return torch.softmax(x, dim=axis)
def _gelu(x):
    return torch.nn.functional.gelu(x, approximate="tanh")
def _silu(x):
    return torch.nn.functional.silu(x)
def _sigmoid(x):
    return torch.sigmoid(x)
def _layernorm(x, axis=-1, eps=1e-5):
    m = x.mean(dim=axis, keepdim=True)
    v = x.var(dim=axis, keepdim=True, unbiased=False)
    return (x - m) / torch.sqrt(v + eps)
def _scatter_add(tgt, idx, src, axis=0):
    return tgt.clone().index_add_(axis, idx, src)
def _segment_sum(src, seg, n):
    out = torch.zeros((n,) + src.shape[1:], dtype=src.dtype)
    return out.index_add_(0, seg, src)
def _pad(x, pw):
    flat = tuple(v for pair in reversed(pw) for v in pair)
    return torch.nn.functional.pad(x, flat)

kernel_name = 'standalone__layernorm_linear__sampling'

def setup_inputs():

    _w = (lambda a: (lambda t: t.to(torch.bfloat16) if t.is_floating_point() else t)(torch.as_tensor(a)))
    B, S, D = 1024, 32, 448
    return {
        "x": _w((lambda *s: torch.randn(*s, dtype=torch.bfloat16) * 0.05)(B, S, D)),
        "g": _w((lambda *s: torch.randn(*s, dtype=torch.bfloat16) * 0.05)(D) + 1.0),
        "b": _w((lambda *s: torch.randn(*s, dtype=torch.bfloat16) * 0.4)(D)),
        "w": _w((lambda *s: torch.randn(*s, dtype=torch.bfloat16) * 0.05)(D, D)),
    }

def reference(x, g, b, w):
    return (_layernorm(x, axis=-1) * g + b) @ w
```

```asm
; @launch grid=(256,1,1) block=(256,1,1) lds=163840
.amdgcn_target "amdgcn-amd-amdhsa--gfx950"
.text
.globl standalone__layernorm_linear__sampling_kernel
.p2align 8
.type standalone__layernorm_linear__sampling_kernel,@function
standalone__layernorm_linear__sampling_kernel:
    s_load_dwordx2 s[16:17], s[0:1], 0
    s_load_dwordx4 s[4:7], s[0:1], 8
    s_load_dwordx2 s[24:25], s[0:1], 24
    s_load_dwordx2 s[28:29], s[0:1], 32
    s_cmp_ge_u32 s2, 256
    s_cbranch_scc1 L_end
    v_lshrrev_b32 v43, 6, v0
    v_and_b32 v40, 63, v0
    v_readfirstlane_b32 s32, v43
    s_lshr_b32 s3, s2, 3
    s_getpc_b64 s[12:13]
    s_getreg_b32 s11, hwreg(HW_REG_HW_ID, 8, 2)
    s_getreg_b32 s14, hwreg(HW_REG_HW_ID, 13, 2)
    s_lshl2_add_u32 s11, s11, s14
    s_lshl2_add_u32 s11, s11, s32
    s_mul_i32 s11, s11, 512
    s_add_u32 s12, s12, s11
    s_addc_u32 s13, s13, 0
    v_min_u32 v48, 3, v40
    v_lshlrev_b32 v48, 7, v48
    v_mov_b32 v49, s13
    v_add_co_u32 v48, vcc, s12, v48
    v_lshlrev_b32 v130, 4, v40
    s_mul_i32 s38, s2, 114688
    v_addc_co_u32 v49, vcc, 0, v49, vcc
    global_load_dword v44, v[48:49], off
    s_mov_b32 s18, 29360128
    s_mov_b32 s19, 0x20000
    s_mul_i32 s37, s32, 28672
    s_add_u32 s37, s37, s38
    s_mul_i32 s36, s32, 40960
    s_movk_i32 s22, 896
    s_mov_b32 s23, 0x20000
    s_movk_i32 s10, 896
    s_mov_b32 s11, 0x20000
    s_mov_b32 s26, 401408
    s_mov_b32 s27, 0x20000
    v_and_b32 v41, 15, v40
    v_lshrrev_b32 v42, 4, v40
    v_mul_u32_u24 v45, 896, v42
    v_lshl_add_u32 v128, v41, 4, v45
    v_lshl_add_u32 v129, v41, 3, v45
    s_waitcnt lgkmcnt(0)
    s_mov_b32 s20, s4
    s_mov_b32 s21, s5
    s_mov_b32 s8, s6
    s_mov_b32 s9, s7
    buffer_load_dwordx4 v[136:139], v130, s[20:23], 0 offen
    buffer_load_dwordx4 v[140:143], v130, s[8:11], 0 offen
    buffer_load_dwordx4 v[228:231], v128, s[16:19], s37 offen offset:0 nt
    buffer_load_dwordx4 v[232:235], v128, s[16:19], s37 offen offset:256 nt
    buffer_load_dwordx4 v[236:239], v128, s[16:19], s37 offen offset:512 nt
    buffer_load_dwordx2 v[240:241], v129, s[16:19], s37 offen offset:768 nt
    s_add_u32 s37, s37, 3584
    buffer_load_dwordx4 v[242:245], v128, s[16:19], s37 offen offset:0 nt
    buffer_load_dwordx4 v[246:249], v128, s[16:19], s37 offen offset:256 nt
    buffer_load_dwordx4 v[250:253], v128, s[16:19], s37 offen offset:512 nt
    buffer_load_dwordx2 v[254:255], v129, s[16:19], s37 offen offset:768 nt
    s_add_u32 s37, s37, 3584
    buffer_load_dwordx4 v[106:109], v128, s[16:19], s37 offen offset:0 nt
    buffer_load_dwordx4 v[110:113], v128, s[16:19], s37 offen offset:256 nt
    buffer_load_dwordx4 v[114:117], v128, s[16:19], s37 offen offset:512 nt
    buffer_load_dwordx2 v[118:119], v129, s[16:19], s37 offen offset:768 nt
    s_mov_b32 s30, 29360128
    s_mov_b32 s31, 0x20000
    s_mov_b32 s33, 0xffff0000
    s_and_b32 s15, s32, 1
    s_mov_b32 s44, 0x3b124925
    v_mov_b32 v127, 0x3727c5ac
    s_sub_u32 s39, s3, 14
    s_min_u32 s3, s3, s39
    s_sub_u32 s39, s3, 14
    s_min_u32 s3, s3, s39
    s_mul_i32 s45, s32, 224
    v_lshlrev_b32 v52, 4, v41
    v_cmp_eq_u32 vcc, 3, v42
    v_lshlrev_b32 v45, 5, v41
    v_mov_b32 v46, 0x100
    v_cndmask_b32 v45, v52, v45, vcc
    v_cndmask_b32_e64 v46, v46, 16, vcc
    v_lshl_add_u32 v50, v42, 9, v45
    v_add_u32 v50, s36, v50
    v_add_u32 v52, s36, v52
    v_add_u32 v51, v50, v46
    s_movk_i32 s12, 0x78
    v_lshrrev_b32 v45, 2, v41
    v_lshlrev_b32 v46, 1, v45
    v_bfe_u32 v46, s12, v46, 2
    v_xor_b32 v46, v46, v42
    v_lshrrev_b32 v47, 1, v46
    v_and_b32 v48, 3, v41
    v_xor_b32 v47, v47, v48
    v_lshlrev_b32 v47, 4, v47
    v_lshl_add_u32 v47, v46, 6, v47
    v_mul_u32_u24 v45, 40960, v45
    v_add_u32 v0, v45, v47
    s_lshl_b32 s41, s32, 1
    s_lshr_b32 s41, s12, s41
    s_and_b32 s41, s41, 3
    v_and_b32 v46, 3, v41
    v_xor_b32 v46, s41, v46
    v_lshrrev_b32 v47, 1, v46
    v_xor_b32 v47, v47, v42
    v_lshlrev_b32 v47, 4, v47
    v_lshl_add_u32 v47, v46, 6, v47
    v_add_u32 v47, s36, v47
    v_lshrrev_b32 v46, 2, v41
    v_subrev_u32 v46, s3, v46
    v_add_u32 v48, 14, v46
    v_min_u32 v48, v48, v46
    v_lshl_add_u32 v120, v48, 10, v47
    v_lshl_add_u32 v1, v48, 8, v47
    v_add_u32 v46, 4, v46
    v_add_u32 v48, 14, v46
    v_min_u32 v48, v48, v46
    v_lshl_add_u32 v121, v48, 10, v47
    v_lshl_add_u32 v2, v48, 8, v47
    v_add_u32 v46, 4, v46
    v_add_u32 v48, 14, v46
    v_min_u32 v48, v48, v46
    v_lshl_add_u32 v122, v48, 10, v47
    v_lshl_add_u32 v3, v48, 8, v47
    v_bfe_u32 v46, v41, 1, 2
    v_xor_b32 v46, s41, v46
    v_lshrrev_b32 v47, 1, v46
    v_xor_b32 v47, v47, v42
    v_lshlrev_b32 v47, 4, v47
    v_lshl_add_u32 v47, v46, 6, v47
    v_add_u32 v47, s36, v47
    v_and_b32 v46, 1, v41
    v_lshl_add_u32 v47, v46, 3, v47
    v_lshrrev_b32 v46, 3, v41
    v_add_u32 v46, 12, v46
    v_subrev_u32 v46, s3, v46
    v_add_u32 v48, 14, v46
    v_min_u32 v48, v48, v46
    v_lshl_add_u32 v123, v48, 10, v47
    v_lshl_add_u32 v4, v48, 8, v47
    s_lshl_b32 s41, s15, 5
    v_lshrrev_b32 v45, 2, v40
    v_mul_u32_u24 v45, 224, v45
    v_and_b32 v46, 3, v40
    v_add_u32 v45, s36, v45
    v_lshl_add_u32 v5, v46, 4, v45
    v_add_u32 v5, s41, v5
    s_mul_i32 s12, s15, 192
    s_sub_u32 s12, 192, s12
    v_lshl_add_u32 v23, v46, 3, v45
    v_add_u32 v23, s12, v23
    s_mul_i32 s34, s3, 28672
    s_add_u32 s34, s34, s45
    s_add_u32 s35, s45, 401408
    s_lshr_b32 s14, s2, 3
    s_lshl_b32 s14, s14, 2
    s_add_u32 s14, s14, s32
    s_mul_i32 s14, s14, 3200
    v_min_u32 v131, 24, v40
    v_lshlrev_b32 v131, 7, v131
    s_movk_i32 s12, 672
    s_movk_i32 s13, 896
    v_mul_u32_u24 v45, 4682, v40
    v_lshrrev_b32 v46, 16, v45
    v_and_b32 v47, 12, v46
    v_mad_u32_u24 v16, v46, s12, v130
    v_mad_u32_u24 v16, v47, s13, v16
    v_add_u32 v46, 299648, v45
    v_lshrrev_b32 v46, 16, v46
    v_and_b32 v47, 12, v46
    v_mad_u32_u24 v17, v46, s12, v130
    v_mad_u32_u24 v17, v47, s13, v17
    v_add_u32 v46, 599296, v45
    v_lshrrev_b32 v46, 16, v46
    v_and_b32 v47, 12, v46
    v_mad_u32_u24 v18, v46, s12, v130
    v_mad_u32_u24 v18, v47, s13, v18
    v_add_u32 v46, 898944, v45
    v_lshrrev_b32 v46, 16, v46
    v_and_b32 v47, 12, v46
    v_mad_u32_u24 v19, v46, s12, v130
    v_mad_u32_u24 v19, v47, s13, v19
    v_lshrrev_b32 v47, 4, v46
    v_mul_u32_u24 v47, 10752, v47
    v_sub_u32 v19, v19, v47
    v_add_u32 v19, 3072, v19
    v_add_u32 v46, 1198592, v45
    v_lshrrev_b32 v46, 16, v46
    v_and_b32 v47, 12, v46
    v_mad_u32_u24 v20, v46, s12, v130
    v_mad_u32_u24 v20, v47, s13, v20
    v_add_u32 v20, 4294959616, v20
    v_add_u32 v46, 1498240, v45
    v_lshrrev_b32 v46, 16, v46
    v_and_b32 v47, 12, v46
    v_mad_u32_u24 v21, v46, s12, v130
    v_mad_u32_u24 v21, v47, s13, v21
    v_add_u32 v21, 4294959616, v21
    v_add_u32 v46, 1797888, v45
    v_lshrrev_b32 v46, 16, v46
    v_and_b32 v47, 12, v46
    v_mad_u32_u24 v22, v46, s12, v130
    v_mad_u32_u24 v22, v47, s13, v22
    v_add_u32 v22, 4294959616, v22
    s_add_u32 s37, s37, 3584
    buffer_load_dwordx4 v[92:95], v128, s[16:19], s37 offen offset:0 nt
    buffer_load_dwordx4 v[96:99], v128, s[16:19], s37 offen offset:256 nt
    buffer_load_dwordx4 v[100:103], v128, s[16:19], s37 offen offset:512 nt
    buffer_load_dwordx2 v[104:105], v129, s[16:19], s37 offen offset:768 nt
    s_waitcnt vmcnt(16)
    v_lshlrev_b32 v56, 16, v136
    v_and_b32 v57, s33, v136
    v_lshlrev_b32 v58, 16, v137
    v_and_b32 v59, s33, v137
    v_lshlrev_b32 v60, 16, v138
    v_and_b32 v61, s33, v138
    v_lshlrev_b32 v62, 16, v139
    v_and_b32 v63, s33, v139
    ds_write_b128 v50, v[56:59] offset:7168
    ds_write_b128 v51, v[60:63] offset:7168
    v_lshlrev_b32 v64, 16, v140
    v_and_b32 v65, s33, v140
    v_lshlrev_b32 v66, 16, v141
    v_and_b32 v67, s33, v141
    v_lshlrev_b32 v68, 16, v142
    v_and_b32 v69, s33, v142
    v_lshlrev_b32 v70, 16, v143
    v_and_b32 v71, s33, v143
    ds_write_b128 v50, v[64:67] offset:9216
    ds_write_b128 v51, v[68:71] offset:9216
    ds_read_b128 v[172:175], v52 offset:7168
    ds_read_b128 v[200:203], v52 offset:9216
    ds_read_b128 v[176:179], v52 offset:7424
    ds_read_b128 v[204:207], v52 offset:9472
    ds_read_b128 v[180:183], v52 offset:7680
    ds_read_b128 v[208:211], v52 offset:9728
    ds_read_b128 v[184:187], v52 offset:7936
    ds_read_b128 v[212:215], v52 offset:9984
    ds_read_b128 v[188:191], v52 offset:8192
    ds_read_b128 v[216:219], v52 offset:10240
    ds_read_b128 v[192:195], v52 offset:8448
    ds_read_b128 v[220:223], v52 offset:10496
    ds_read_b128 v[196:199], v52 offset:8704
    ds_read_b128 v[224:227], v52 offset:10752
    s_waitcnt vmcnt(15)
    v_lshlrev_b32 v144, 16, v228
    v_and_b32 v145, s33, v228
    v_lshlrev_b32 v146, 16, v229
    v_and_b32 v147, s33, v229
    v_mov_b32_dpp v136, v144 row_newbcast:0 row_mask:0xf bank_mask:0xf
    v_lshlrev_b32 v148, 16, v230
    v_and_b32 v149, s33, v230
    v_pk_add_f32 v[144:145], v[144:145], v[136:137] op_sel_hi:[1,0] neg_lo:[0,1] neg_hi:[0,1]
    v_lshlrev_b32 v150, 16, v231
    v_and_b32 v151, s33, v231
    v_pk_add_f32 v[146:147], v[146:147], v[136:137] op_sel_hi:[1,0] neg_lo:[0,1] neg_hi:[0,1]
    v_pk_mul_f32 v[134:135], v[144:145], v[144:145]
    s_waitcnt vmcnt(14)
    v_lshlrev_b32 v152, 16, v232
    v_and_b32 v153, s33, v232
    v_pk_add_f32 v[148:149], v[148:149], v[136:137] op_sel_hi:[1,0] neg_lo:[0,1] neg_hi:[0,1]
    v_pk_add_f32 v[132:133], v[144:145], v[146:147]
    v_pk_fma_f32 v[134:135], v[146:147], v[146:147], v[134:135]
    v_lshlrev_b32 v154, 16, v233
    v_and_b32 v155, s33, v233
    v_pk_add_f32 v[150:151], v[150:151], v[136:137] op_sel_hi:[1,0] neg_lo:[0,1] neg_hi:[0,1]
    v_pk_add_f32 v[132:133], v[132:133], v[148:149]
    v_pk_fma_f32 v[134:135], v[148:149], v[148:149], v[134:135]
    v_lshlrev_b32 v156, 16, v234
    v_and_b32 v157, s33, v234
    v_pk_add_f32 v[152:153], v[152:153], v[136:137] op_sel_hi:[1,0] neg_lo:[0,1] neg_hi:[0,1]
    v_pk_add_f32 v[132:133], v[132:133], v[150:151]
    v_pk_fma_f32 v[134:135], v[150:151], v[150:151], v[134:135]
    v_lshlrev_b32 v158, 16, v235
    v_and_b32 v159, s33, v235
    v_pk_add_f32 v[154:155], v[154:155], v[136:137] op_sel_hi:[1,0] neg_lo:[0,1] neg_hi:[0,1]
    v_pk_add_f32 v[132:133], v[132:133], v[152:153]
    v_pk_fma_f32 v[134:135], v[152:153], v[152:153], v[134:135]
    s_waitcnt vmcnt(13)
    v_lshlrev_b32 v160, 16, v236
    v_and_b32 v161, s33, v236
    v_pk_add_f32 v[156:157], v[156:157], v[136:137] op_sel_hi:[1,0] neg_lo:[0,1] neg_hi:[0,1]
    v_pk_add_f32 v[132:133], v[132:133], v[154:155]
    v_pk_fma_f32 v[134:135], v[154:155], v[154:155], v[134:135]
    v_lshlrev_b32 v162, 16, v237
    v_and_b32 v163, s33, v237
    v_pk_add_f32 v[158:159], v[158:159], v[136:137] op_sel_hi:[1,0] neg_lo:[0,1] neg_hi:[0,1]
    v_pk_add_f32 v[132:133], v[132:133], v[156:157]
    v_pk_fma_f32 v[134:135], v[156:157], v[156:157], v[134:135]
    v_lshlrev_b32 v164, 16, v238
    v_and_b32 v165, s33, v238
    v_pk_add_f32 v[160:161], v[160:161], v[136:137] op_sel_hi:[1,0] neg_lo:[0,1] neg_hi:[0,1]
    v_pk_add_f32 v[132:133], v[132:133], v[158:159]
    v_pk_fma_f32 v[134:135], v[158:159], v[158:159], v[134:135]
    v_lshlrev_b32 v166, 16, v239
    v_and_b32 v167, s33, v239
    v_pk_add_f32 v[162:163], v[162:163], v[136:137] op_sel_hi:[1,0] neg_lo:[0,1] neg_hi:[0,1]
    v_pk_add_f32 v[132:133], v[132:133], v[160:161]
    v_pk_fma_f32 v[134:135], v[160:161], v[160:161], v[134:135]
    s_waitcnt vmcnt(12)
    v_lshlrev_b32 v168, 16, v240
    v_and_b32 v169, s33, v240
    v_pk_add_f32 v[164:165], v[164:165], v[136:137] op_sel_hi:[1,0] neg_lo:[0,1] neg_hi:[0,1]
    v_pk_add_f32 v[132:133], v[132:133], v[162:163]
    v_pk_fma_f32 v[134:135], v[162:163], v[162:163], v[134:135]
    v_lshlrev_b32 v170, 16, v241
    v_and_b32 v171, s33, v241
    v_pk_add_f32 v[166:167], v[166:167], v[136:137] op_sel_hi:[1,0] neg_lo:[0,1] neg_hi:[0,1]
    v_pk_add_f32 v[132:133], v[132:133], v[164:165]
    v_pk_fma_f32 v[134:135], v[164:165], v[164:165], v[134:135]
    v_pk_add_f32 v[168:169], v[168:169], v[136:137] op_sel_hi:[1,0] neg_lo:[0,1] neg_hi:[0,1]
    v_pk_add_f32 v[132:133], v[132:133], v[166:167]
    v_pk_fma_f32 v[134:135], v[166:167], v[166:167], v[134:135]
    v_pk_add_f32 v[170:171], v[170:171], v[136:137] op_sel_hi:[1,0] neg_lo:[0,1] neg_hi:[0,1]
    v_pk_add_f32 v[132:133], v[132:133], v[168:169]
    v_pk_fma_f32 v[134:135], v[168:169], v[168:169], v[134:135]
    v_pk_add_f32 v[132:133], v[132:133], v[170:171]
    v_pk_fma_f32 v[134:135], v[170:171], v[170:171], v[134:135]
    v_add_f32 v132, v132, v133
    v_add_f32 v134, v134, v135
    s_add_u32 s37, s37, 3584
    buffer_load_dwordx4 v[78:81], v128, s[16:19], s37 offen offset:0 nt
    v_add_f32_dpp v132, v132, v132 row_ror:8 row_mask:0xf bank_mask:0xf
    v_add_f32_dpp v134, v134, v134 row_ror:8 row_mask:0xf bank_mask:0xf
    s_nop 0
    v_add_f32_dpp v132, v132, v132 row_ror:4 row_mask:0xf bank_mask:0xf
    v_add_f32_dpp v134, v134, v134 row_ror:4 row_mask:0xf bank_mask:0xf
    s_nop 0
    v_add_f32_dpp v132, v132, v132 row_ror:2 row_mask:0xf bank_mask:0xf
    v_add_f32_dpp v134, v134, v134 row_ror:2 row_mask:0xf bank_mask:0xf
    buffer_load_dwordx4 v[82:85], v128, s[16:19], s37 offen offset:256 nt
    v_add_f32_dpp v132, v132, v132 row_ror:1 row_mask:0xf bank_mask:0xf
    v_add_f32_dpp v134, v134, v134 row_ror:1 row_mask:0xf bank_mask:0xf
    v_mul_f32 v132, s44, v132
    v_mul_f32 v134, s44, v134
    v_add_f32 v133, v136, v132
    v_fma_f32 v134, -v132, v132, v134
    v_cvt_pk_bf16_f32 v133, v133, v133
    v_max_f32 v134, 0, v134
    v_and_b32 v133, s33, v133
    v_add_f32 v134, v127, v134
    v_rsq_f32 v135, v134
    v_sub_f32 v133, v136, v133
    v_mul_f32 v133, v133, v135
    s_waitcnt lgkmcnt(0)
    v_pk_fma_f32 v[144:145], v[144:145], v[134:135], v[132:133] op_sel:[0,1,1] op_sel_hi:[1,1,1]
    v_pk_fma_f32 v[146:147], v[146:147], v[134:135], v[132:133] op_sel:[0,1,1] op_sel_hi:[1,1,1]
    v_pk_fma_f32 v[148:149], v[148:149], v[134:135], v[132:133] op_sel:[0,1,1] op_sel_hi:[1,1,1]
    v_pk_fma_f32 v[150:151], v[150:151], v[134:135], v[132:133] op_sel:[0,1,1] op_sel_hi:[1,1,1]
    v_pk_fma_f32 v[144:145], v[144:145], v[172:173], v[200:201]
    v_pk_fma_f32 v[146:147], v[146:147], v[174:175], v[202:203]
    v_pk_fma_f32 v[148:149], v[148:149], v[176:177], v[204:205]
    v_pk_fma_f32 v[150:151], v[150:151], v[178:179], v[206:207]
    v_cvt_pk_bf16_f32 v228, v144, v145
    v_cvt_pk_bf16_f32 v229, v146, v147
    v_cvt_pk_bf16_f32 v230, v148, v149
    v_cvt_pk_bf16_f32 v231, v150, v151
    v_pk_fma_f32 v[152:153], v[152:153], v[134:135], v[132:133] op_sel:[0,1,1] op_sel_hi:[1,1,1]
    v_pk_fma_f32 v[154:155], v[154:155], v[134:135], v[132:133] op_sel:[0,1,1] op_sel_hi:[1,1,1]
    v_pk_fma_f32 v[156:157], v[156:157], v[134:135], v[132:133] op_sel:[0,1,1] op_sel_hi:[1,1,1]
    v_pk_fma_f32 v[158:159], v[158:159], v[134:135], v[132:133] op_sel:[0,1,1] op_sel_hi:[1,1,1]
    v_pk_fma_f32 v[152:153], v[152:153], v[180:181], v[208:209]
    v_pk_fma_f32 v[154:155], v[154:155], v[182:183], v[210:211]
    v_pk_fma_f32 v[156:157], v[156:157], v[184:185], v[212:213]
    v_pk_fma_f32 v[158:159], v[158:159], v[186:187], v[214:215]
    buffer_load_dwordx4 v[86:89], v128, s[16:19], s37 offen offset:512 nt
    v_cvt_pk_bf16_f32 v232, v152, v153
    v_cvt_pk_bf16_f32 v233, v154, v155
    v_cvt_pk_bf16_f32 v234, v156, v157
    v_cvt_pk_bf16_f32 v235, v158, v159
    v_pk_fma_f32 v[160:161], v[160:161], v[134:135], v[132:133] op_sel:[0,1,1] op_sel_hi:[1,1,1]
    v_pk_fma_f32 v[162:163], v[162:163], v[134:135], v[132:133] op_sel:[0,1,1] op_sel_hi:[1,1,1]
    v_pk_fma_f32 v[164:165], v[164:165], v[134:135], v[132:133] op_sel:[0,1,1] op_sel_hi:[1,1,1]
    v_pk_fma_f32 v[166:167], v[166:167], v[134:135], v[132:133] op_sel:[0,1,1] op_sel_hi:[1,1,1]
    v_pk_fma_f32 v[160:161], v[160:161], v[188:189], v[216:217]
    v_pk_fma_f32 v[162:163], v[162:163], v[190:191], v[218:219]
    v_pk_fma_f32 v[164:165], v[164:165], v[192:193], v[220:221]
    v_pk_fma_f32 v[166:167], v[166:167], v[194:195], v[222:223]
    v_cvt_pk_bf16_f32 v236, v160, v161
    v_cvt_pk_bf16_f32 v237, v162, v163
    v_cvt_pk_bf16_f32 v238, v164, v165
    v_cvt_pk_bf16_f32 v239, v166, v167
    v_pk_fma_f32 v[168:169], v[168:169], v[134:135], v[132:133] op_sel:[0,1,1] op_sel_hi:[1,1,1]
    v_pk_fma_f32 v[170:171], v[170:171], v[134:135], v[132:133] op_sel:[0,1,1] op_sel_hi:[1,1,1]
    v_pk_fma_f32 v[168:169], v[168:169], v[196:197], v[224:225]
    v_pk_fma_f32 v[170:171], v[170:171], v[198:199], v[226:227]
    v_cvt_pk_bf16_f32 v240, v168, v169
    v_cvt_pk_bf16_f32 v241, v170, v171
    ds_write_b128 v120, v[228:231] offset:15872
    ds_write_b128 v121, v[232:235] offset:15872
    ds_write_b128 v122, v[236:239] offset:15872
    ds_write_b64 v123, v[240:241] offset:15872
    buffer_load_dwordx2 v[90:91], v129, s[16:19], s37 offen offset:768 nt
    s_waitcnt vmcnt(15)
    v_lshlrev_b32 v144, 16, v242
    v_and_b32 v145, s33, v242
    v_lshlrev_b32 v146, 16, v243
    v_and_b32 v147, s33, v243
    v_mov_b32_dpp v136, v144 row_newbcast:0 row_mask:0xf bank_mask:0xf
    v_lshlrev_b32 v148, 16, v244
    v_and_b32 v149, s33, v244
    v_pk_add_f32 v[144:145], v[144:145], v[136:137] op_sel_hi:[1,0] neg_lo:[0,1] neg_hi:[0,1]
    v_lshlrev_b32 v150, 16, v245
    v_and_b32 v151, s33, v245
    v_pk_add_f32 v[146:147], v[146:147], v[136:137] op_sel_hi:[1,0] neg_lo:[0,1] neg_hi:[0,1]
    v_pk_mul_f32 v[134:135], v[144:145], v[144:145]
    s_waitcnt vmcnt(14)
    v_lshlrev_b32 v152, 16, v246
    v_and_b32 v153, s33, v246
    v_pk_add_f32 v[148:149], v[148:149], v[136:137] op_sel_hi:[1,0] neg_lo:[0,1] neg_hi:[0,1]
    v_pk_add_f32 v[132:133], v[144:145], v[146:147]
    v_pk_fma_f32 v[134:135], v[146:147], v[146:147], v[134:135]
    v_lshlrev_b32 v154, 16, v247
    v_and_b32 v155, s33, v247
    v_pk_add_f32 v[150:151], v[150:151], v[136:137] op_sel_hi:[1,0] neg_lo:[0,1] neg_hi:[0,1]
    v_pk_add_f32 v[132:133], v[132:133], v[148:149]
    v_pk_fma_f32 v[134:135], v[148:149], v[148:149], v[134:135]
    v_lshlrev_b32 v156, 16, v248
    v_and_b32 v157, s33, v248
    v_pk_add_f32 v[152:153], v[152:153], v[136:137] op_sel_hi:[1,0] neg_lo:[0,1] neg_hi:[0,1]
    v_pk_add_f32 v[132:133], v[132:133], v[150:151]
    v_pk_fma_f32 v[134:135], v[150:151], v[150:151], v[134:135]
    v_lshlrev_b32 v158, 16, v249
    v_and_b32 v159, s33, v249
    v_pk_add_f32 v[154:155], v[154:155], v[136:137] op_sel_hi:[1,0] neg_lo:[0,1] neg_hi:[0,1]
    v_pk_add_f32 v[132:133], v[132:133], v[152:153]
    v_pk_fma_f32 v[134:135], v[152:153], v[152:153], v[134:135]
    s_waitcnt vmcnt(13)
    v_lshlrev_b32 v160, 16, v250
    v_and_b32 v161, s33, v250
    v_pk_add_f32 v[156:157], v[156:157], v[136:137] op_sel_hi:[1,0] neg_lo:[0,1] neg_hi:[0,1]
    v_pk_add_f32 v[132:133], v[132:133], v[154:155]
    v_pk_fma_f32 v[134:135], v[154:155], v[154:155], v[134:135]
    v_lshlrev_b32 v162, 16, v251
    v_and_b32 v163, s33, v251
    v_pk_add_f32 v[158:159], v[158:159], v[136:137] op_sel_hi:[1,0] neg_lo:[0,1] neg_hi:[0,1]
    v_pk_add_f32 v[132:133], v[132:133], v[156:157]
    v_pk_fma_f32 v[134:135], v[156:157], v[156:157], v[134:135]
    v_lshlrev_b32 v164, 16, v252
    v_and_b32 v165, s33, v252
    v_pk_add_f32 v[160:161], v[160:161], v[136:137] op_sel_hi:[1,0] neg_lo:[0,1] neg_hi:[0,1]
    v_pk_add_f32 v[132:133], v[132:133], v[158:159]
    v_pk_fma_f32 v[134:135], v[158:159], v[158:159], v[134:135]
    v_lshlrev_b32 v166, 16, v253
    v_and_b32 v167, s33, v253
    v_pk_add_f32 v[162:163], v[162:163], v[136:137] op_sel_hi:[1,0] neg_lo:[0,1] neg_hi:[0,1]
    v_pk_add_f32 v[132:133], v[132:133], v[160:161]
    v_pk_fma_f32 v[134:135], v[160:161], v[160:161], v[134:135]
    s_waitcnt vmcnt(12)
    v_lshlrev_b32 v168, 16, v254
    v_and_b32 v169, s33, v254
    v_pk_add_f32 v[164:165], v[164:165], v[136:137] op_sel_hi:[1,0] neg_lo:[0,1] neg_hi:[0,1]
    v_pk_add_f32 v[132:133], v[132:133], v[162:163]
    v_pk_fma_f32 v[134:135], v[162:163], v[162:163], v[134:135]
    v_lshlrev_b32 v170, 16, v255
    v_and_b32 v171, s33, v255
    v_pk_add_f32 v[166:167], v[166:167], v[136:137] op_sel_hi:[1,0] neg_lo:[0,1] neg_hi:[0,1]
    v_pk_add_f32 v[132:133], v[132:133], v[164:165]
    v_pk_fma_f32 v[134:135], v[164:165], v[164:165], v[134:135]
    v_pk_add_f32 v[168:169], v[168:169], v[136:137] op_sel_hi:[1,0] neg_lo:[0,1] neg_hi:[0,1]
    v_pk_add_f32 v[132:133], v[132:133], v[166:167]
    v_pk_fma_f32 v[134:135], v[166:167], v[166:167], v[134:135]
    v_pk_add_f32 v[170:171], v[170:171], v[136:137] op_sel_hi:[1,0] neg_lo:[0,1] neg_hi:[0,1]
    v_pk_add_f32 v[132:133], v[132:133], v[168:169]
    v_pk_fma_f32 v[134:135], v[168:169], v[168:169], v[134:135]
    v_pk_add_f32 v[132:133], v[132:133], v[170:171]
    v_pk_fma_f32 v[134:135], v[170:171], v[170:171], v[134:135]
    v_add_f32 v132, v132, v133
    v_add_f32 v134, v134, v135
    s_add_u32 s37, s37, 3584
    buffer_load_dwordx4 v[64:67], v128, s[16:19], s37 offen offset:0 nt
    v_add_f32_dpp v132, v132, v132 row_ror:8 row_mask:0xf bank_mask:0xf
    v_add_f32_dpp v134, v134, v134 row_ror:8 row_mask:0xf bank_mask:0xf
    s_nop 0
    v_add_f32_dpp v132, v132, v132 row_ror:4 row_mask:0xf bank_mask:0xf
    v_add_f32_dpp v134, v134, v134 row_ror:4 row_mask:0xf bank_mask:0xf
    s_nop 0
    v_add_f32_dpp v132, v132, v132 row_ror:2 row_mask:0xf bank_mask:0xf
    v_add_f32_dpp v134, v134, v134 row_ror:2 row_mask:0xf bank_mask:0xf
    buffer_load_dwordx4 v[68:71], v128, s[16:19], s37 offen offset:256 nt
    v_add_f32_dpp v132, v132, v132 row_ror:1 row_mask:0xf bank_mask:0xf
    v_add_f32_dpp v134, v134, v134 row_ror:1 row_mask:0xf bank_mask:0xf
    v_mul_f32 v132, s44, v132
    v_mul_f32 v134, s44, v134
    v_add_f32 v133, v136, v132
    v_fma_f32 v134, -v132, v132, v134
    v_cvt_pk_bf16_f32 v133, v133, v133
    v_max_f32 v134, 0, v134
    v_and_b32 v133, s33, v133
    v_add_f32 v134, v127, v134
    v_rsq_f32 v135, v134
    v_sub_f32 v133, v136, v133
    v_mul_f32 v133, v133, v135
    v_pk_fma_f32 v[144:145], v[144:145], v[134:135], v[132:133] op_sel:[0,1,1] op_sel_hi:[1,1,1]
    v_pk_fma_f32 v[146:147], v[146:147], v[134:135], v[132:133] op_sel:[0,1,1] op_sel_hi:[1,1,1]
    v_pk_fma_f32 v[148:149], v[148:149], v[134:135], v[132:133] op_sel:[0,1,1] op_sel_hi:[1,1,1]
    v_pk_fma_f32 v[150:151], v[150:151], v[134:135], v[132:133] op_sel:[0,1,1] op_sel_hi:[1,1,1]
    v_pk_fma_f32 v[144:145], v[144:145], v[172:173], v[200:201]
    v_pk_fma_f32 v[146:147], v[146:147], v[174:175], v[202:203]
    v_pk_fma_f32 v[148:149], v[148:149], v[176:177], v[204:205]
    v_pk_fma_f32 v[150:151], v[150:151], v[178:179], v[206:207]
    v_cvt_pk_bf16_f32 v242, v144, v145
    v_cvt_pk_bf16_f32 v243, v146, v147
    v_cvt_pk_bf16_f32 v244, v148, v149
    v_cvt_pk_bf16_f32 v245, v150, v151
    v_pk_fma_f32 v[152:153], v[152:153], v[134:135], v[132:133] op_sel:[0,1,1] op_sel_hi:[1,1,1]
    v_pk_fma_f32 v[154:155], v[154:155], v[134:135], v[132:133] op_sel:[0,1,1] op_sel_hi:[1,1,1]
    v_pk_fma_f32 v[156:157], v[156:157], v[134:135], v[132:133] op_sel:[0,1,1] op_sel_hi:[1,1,1]
    v_pk_fma_f32 v[158:159], v[158:159], v[134:135], v[132:133] op_sel:[0,1,1] op_sel_hi:[1,1,1]
    v_pk_fma_f32 v[152:153], v[152:153], v[180:181], v[208:209]
    v_pk_fma_f32 v[154:155], v[154:155], v[182:183], v[210:211]
    v_pk_fma_f32 v[156:157], v[156:157], v[184:185], v[212:213]
    v_pk_fma_f32 v[158:159], v[158:159], v[186:187], v[214:215]
    buffer_load_dwordx4 v[72:75], v128, s[16:19], s37 offen offset:512 nt
    v_cvt_pk_bf16_f32 v246, v152, v153
    v_cvt_pk_bf16_f32 v247, v154, v155
    v_cvt_pk_bf16_f32 v248, v156, v157
    v_cvt_pk_bf16_f32 v249, v158, v159
    v_pk_fma_f32 v[160:161], v[160:161], v[134:135], v[132:133] op_sel:[0,1,1] op_sel_hi:[1,1,1]
    v_pk_fma_f32 v[162:163], v[162:163], v[134:135], v[132:133] op_sel:[0,1,1] op_sel_hi:[1,1,1]
    v_pk_fma_f32 v[164:165], v[164:165], v[134:135], v[132:133] op_sel:[0,1,1] op_sel_hi:[1,1,1]
    v_pk_fma_f32 v[166:167], v[166:167], v[134:135], v[132:133] op_sel:[0,1,1] op_sel_hi:[1,1,1]
    v_pk_fma_f32 v[160:161], v[160:161], v[188:189], v[216:217]
    v_pk_fma_f32 v[162:163], v[162:163], v[190:191], v[218:219]
    v_pk_fma_f32 v[164:165], v[164:165], v[192:193], v[220:221]
    v_pk_fma_f32 v[166:167], v[166:167], v[194:195], v[222:223]
    v_cvt_pk_bf16_f32 v250, v160, v161
    v_cvt_pk_bf16_f32 v251, v162, v163
    v_cvt_pk_bf16_f32 v252, v164, v165
    v_cvt_pk_bf16_f32 v253, v166, v167
    v_pk_fma_f32 v[168:169], v[168:169], v[134:135], v[132:133] op_sel:[0,1,1] op_sel_hi:[1,1,1]
    v_pk_fma_f32 v[170:171], v[170:171], v[134:135], v[132:133] op_sel:[0,1,1] op_sel_hi:[1,1,1]
    v_pk_fma_f32 v[168:169], v[168:169], v[196:197], v[224:225]
    v_pk_fma_f32 v[170:171], v[170:171], v[198:199], v[226:227]
    v_cvt_pk_bf16_f32 v254, v168, v169
    v_cvt_pk_bf16_f32 v255, v170, v171
    ds_write_b128 v120, v[242:245] offset:16128
    ds_write_b128 v121, v[246:249] offset:16128
    ds_write_b128 v122, v[250:253] offset:16128
    ds_write_b64 v123, v[254:255] offset:16128
    buffer_load_dwordx2 v[76:77], v129, s[16:19], s37 offen offset:768 nt
    s_branch L_main
.p2align 12
.fill 0, 4, 0xbf810000
L_main:
    s_waitcnt vmcnt(15)
    v_lshlrev_b32 v144, 16, v106
    v_and_b32 v145, s33, v106
    v_lshlrev_b32 v146, 16, v107
    v_and_b32 v147, s33, v107
    v_mov_b32_dpp v136, v144 row_newbcast:0 row_mask:0xf bank_mask:0xf
    v_lshlrev_b32 v148, 16, v108
    v_and_b32 v149, s33, v108
    v_pk_add_f32 v[144:145], v[144:145], v[136:137] op_sel_hi:[1,0] neg_lo:[0,1] neg_hi:[0,1]
    v_lshlrev_b32 v150, 16, v109
    v_and_b32 v151, s33, v109
    v_pk_add_f32 v[146:147], v[146:147], v[136:137] op_sel_hi:[1,0] neg_lo:[0,1] neg_hi:[0,1]
    v_pk_mul_f32 v[134:135], v[144:145], v[144:145]
    s_waitcnt vmcnt(14)
    v_lshlrev_b32 v152, 16, v110
    v_and_b32 v153, s33, v110
    v_pk_add_f32 v[148:149], v[148:149], v[136:137] op_sel_hi:[1,0] neg_lo:[0,1] neg_hi:[0,1]
    v_pk_add_f32 v[132:133], v[144:145], v[146:147]
    v_pk_fma_f32 v[134:135], v[146:147], v[146:147], v[134:135]
    v_lshlrev_b32 v154, 16, v111
    v_and_b32 v155, s33, v111
    v_pk_add_f32 v[150:151], v[150:151], v[136:137] op_sel_hi:[1,0] neg_lo:[0,1] neg_hi:[0,1]
    v_pk_add_f32 v[132:133], v[132:133], v[148:149]
    v_pk_fma_f32 v[134:135], v[148:149], v[148:149], v[134:135]
    v_lshlrev_b32 v156, 16, v112
    v_and_b32 v157, s33, v112
    v_pk_add_f32 v[152:153], v[152:153], v[136:137] op_sel_hi:[1,0] neg_lo:[0,1] neg_hi:[0,1]
    v_pk_add_f32 v[132:133], v[132:133], v[150:151]
    v_pk_fma_f32 v[134:135], v[150:151], v[150:151], v[134:135]
    v_lshlrev_b32 v158, 16, v113
    v_and_b32 v159, s33, v113
    v_pk_add_f32 v[154:155], v[154:155], v[136:137] op_sel_hi:[1,0] neg_lo:[0,1] neg_hi:[0,1]
    v_pk_add_f32 v[132:133], v[132:133], v[152:153]
    v_pk_fma_f32 v[134:135], v[152:153], v[152:153], v[134:135]
    s_waitcnt vmcnt(13)
    v_lshlrev_b32 v160, 16, v114
    v_and_b32 v161, s33, v114
    v_pk_add_f32 v[156:157], v[156:157], v[136:137] op_sel_hi:[1,0] neg_lo:[0,1] neg_hi:[0,1]
    v_pk_add_f32 v[132:133], v[132:133], v[154:155]
    v_pk_fma_f32 v[134:135], v[154:155], v[154:155], v[134:135]
    v_lshlrev_b32 v162, 16, v115
    v_and_b32 v163, s33, v115
    v_pk_add_f32 v[158:159], v[158:159], v[136:137] op_sel_hi:[1,0] neg_lo:[0,1] neg_hi:[0,1]
    v_pk_add_f32 v[132:133], v[132:133], v[156:157]
    v_pk_fma_f32 v[134:135], v[156:157], v[156:157], v[134:135]
    v_lshlrev_b32 v164, 16, v116
    v_and_b32 v165, s33, v116
    v_pk_add_f32 v[160:161], v[160:161], v[136:137] op_sel_hi:[1,0] neg_lo:[0,1] neg_hi:[0,1]
    v_pk_add_f32 v[132:133], v[132:133], v[158:159]
    v_pk_fma_f32 v[134:135], v[158:159], v[158:159], v[134:135]
    v_lshlrev_b32 v166, 16, v117
    v_and_b32 v167, s33, v117
    v_pk_add_f32 v[162:163], v[162:163], v[136:137] op_sel_hi:[1,0] neg_lo:[0,1] neg_hi:[0,1]
    v_pk_add_f32 v[132:133], v[132:133], v[160:161]
    v_pk_fma_f32 v[134:135], v[160:161], v[160:161], v[134:135]
    s_waitcnt vmcnt(12)
    v_lshlrev_b32 v168, 16, v118
    v_and_b32 v169, s33, v118
    v_pk_add_f32 v[164:165], v[164:165], v[136:137] op_sel_hi:[1,0] neg_lo:[0,1] neg_hi:[0,1]
    v_pk_add_f32 v[132:133], v[132:133], v[162:163]
    v_pk_fma_f32 v[134:135], v[162:163], v[162:163], v[134:135]
    v_lshlrev_b32 v170, 16, v119
    v_and_b32 v171, s33, v119
    v_pk_add_f32 v[166:167], v[166:167], v[136:137] op_sel_hi:[1,0] neg_lo:[0,1] neg_hi:[0,1]
    v_pk_add_f32 v[132:133], v[132:133], v[164:165]
    v_pk_fma_f32 v[134:135], v[164:165], v[164:165], v[134:135]
    v_pk_add_f32 v[168:169], v[168:169], v[136:137] op_sel_hi:[1,0] neg_lo:[0,1] neg_hi:[0,1]
    v_pk_add_f32 v[132:133], v[132:133], v[166:167]
    v_pk_fma_f32 v[134:135], v[166:167], v[166:167], v[134:135]
    v_pk_add_f32 v[170:171], v[170:171], v[136:137] op_sel_hi:[1,0] neg_lo:[0,1] neg_hi:[0,1]
    v_pk_add_f32 v[132:133], v[132:133], v[168:169]
    v_pk_fma_f32 v[134:135], v[168:169], v[168:169], v[134:135]
    v_pk_add_f32 v[132:133], v[132:133], v[170:171]
    v_pk_fma_f32 v[134:135], v[170:171], v[170:171], v[134:135]
    v_add_f32 v132, v132, v133
    v_add_f32 v134, v134, v135
    s_add_u32 s37, s37, 3584
    buffer_load_dwordx4 v[50:53], v128, s[16:19], s37 offen offset:0 nt
    v_add_f32_dpp v132, v132, v132 row_ror:8 row_mask:0xf bank_mask:0xf
    v_add_f32_dpp v134, v134, v134 row_ror:8 row_mask:0xf bank_mask:0xf
    s_nop 0
    v_add_f32_dpp v132, v132, v132 row_ror:4 row_mask:0xf bank_mask:0xf
    v_add_f32_dpp v134, v134, v134 row_ror:4 row_mask:0xf bank_mask:0xf
    s_nop 0
    v_add_f32_dpp v132, v132, v132 row_ror:2 row_mask:0xf bank_mask:0xf
    v_add_f32_dpp v134, v134, v134 row_ror:2 row_mask:0xf bank_mask:0xf
    buffer_load_dwordx4 v[54:57], v128, s[16:19], s37 offen offset:256 nt
    v_add_f32_dpp v132, v132, v132 row_ror:1 row_mask:0xf bank_mask:0xf
    v_add_f32_dpp v134, v134, v134 row_ror:1 row_mask:0xf bank_mask:0xf
    v_mul_f32 v132, s44, v132
    v_mul_f32 v134, s44, v134
    v_add_f32 v133, v136, v132
    v_fma_f32 v134, -v132, v132, v134
    v_cvt_pk_bf16_f32 v133, v133, v133
    v_max_f32 v134, 0, v134
    v_and_b32 v133, s33, v133
    v_add_f32 v134, v127, v134
    v_rsq_f32 v135, v134
    v_sub_f32 v133, v136, v133
    v_mul_f32 v133, v133, v135
    v_pk_fma_f32 v[144:145], v[144:145], v[134:135], v[132:133] op_sel:[0,1,1] op_sel_hi:[1,1,1]
    v_pk_fma_f32 v[146:147], v[146:147], v[134:135], v[132:133] op_sel:[0,1,1] op_sel_hi:[1,1,1]
    v_pk_fma_f32 v[148:149], v[148:149], v[134:135], v[132:133] op_sel:[0,1,1] op_sel_hi:[1,1,1]
    v_pk_fma_f32 v[150:151], v[150:151], v[134:135], v[132:133] op_sel:[0,1,1] op_sel_hi:[1,1,1]
    v_pk_fma_f32 v[144:145], v[144:145], v[172:173], v[200:201]
    v_pk_fma_f32 v[146:147], v[146:147], v[174:175], v[202:203]
    v_pk_fma_f32 v[148:149], v[148:149], v[176:177], v[204:205]
    v_pk_fma_f32 v[150:151], v[150:151], v[178:179], v[206:207]
    v_cvt_pk_bf16_f32 v106, v144, v145
    v_cvt_pk_bf16_f32 v107, v146, v147
    v_cvt_pk_bf16_f32 v108, v148, v149
    v_cvt_pk_bf16_f32 v109, v150, v151
    v_pk_fma_f32 v[152:153], v[152:153], v[134:135], v[132:133] op_sel:[0,1,1] op_sel_hi:[1,1,1]
    v_pk_fma_f32 v[154:155], v[154:155], v[134:135], v[132:133] op_sel:[0,1,1] op_sel_hi:[1,1,1]
    v_pk_fma_f32 v[156:157], v[156:157], v[134:135], v[132:133] op_sel:[0,1,1] op_sel_hi:[1,1,1]
    v_pk_fma_f32 v[158:159], v[158:159], v[134:135], v[132:133] op_sel:[0,1,1] op_sel_hi:[1,1,1]
    v_pk_fma_f32 v[152:153], v[152:153], v[180:181], v[208:209]
    v_pk_fma_f32 v[154:155], v[154:155], v[182:183], v[210:211]
    v_pk_fma_f32 v[156:157], v[156:157], v[184:185], v[212:213]
    v_pk_fma_f32 v[158:159], v[158:159], v[186:187], v[214:215]
    buffer_load_dwordx4 v[58:61], v128, s[16:19], s37 offen offset:512 nt
    v_cvt_pk_bf16_f32 v110, v152, v153
    v_cvt_pk_bf16_f32 v111, v154, v155
    v_cvt_pk_bf16_f32 v112, v156, v157
    v_cvt_pk_bf16_f32 v113, v158, v159
    v_pk_fma_f32 v[160:161], v[160:161], v[134:135], v[132:133] op_sel:[0,1,1] op_sel_hi:[1,1,1]
    v_pk_fma_f32 v[162:163], v[162:163], v[134:135], v[132:133] op_sel:[0,1,1] op_sel_hi:[1,1,1]
    v_pk_fma_f32 v[164:165], v[164:165], v[134:135], v[132:133] op_sel:[0,1,1] op_sel_hi:[1,1,1]
    v_pk_fma_f32 v[166:167], v[166:167], v[134:135], v[132:133] op_sel:[0,1,1] op_sel_hi:[1,1,1]
    v_pk_fma_f32 v[160:161], v[160:161], v[188:189], v[216:217]
    v_pk_fma_f32 v[162:163], v[162:163], v[190:191], v[218:219]
    v_pk_fma_f32 v[164:165], v[164:165], v[192:193], v[220:221]
    v_pk_fma_f32 v[166:167], v[166:167], v[194:195], v[222:223]
    v_cvt_pk_bf16_f32 v114, v160, v161
    v_cvt_pk_bf16_f32 v115, v162, v163
    v_cvt_pk_bf16_f32 v116, v164, v165
    v_cvt_pk_bf16_f32 v117, v166, v167
    v_pk_fma_f32 v[168:169], v[168:169], v[134:135], v[132:133] op_sel:[0,1,1] op_sel_hi:[1,1,1]
    v_pk_fma_f32 v[170:171], v[170:171], v[134:135], v[132:133] op_sel:[0,1,1] op_sel_hi:[1,1,1]
    v_pk_fma_f32 v[168:169], v[168:169], v[196:197], v[224:225]
    v_pk_fma_f32 v[170:171], v[170:171], v[198:199], v[226:227]
    v_cvt_pk_bf16_f32 v118, v168, v169
    v_cvt_pk_bf16_f32 v119, v170, v171
    ds_write_b128 v120, v[106:109] offset:16384
    ds_write_b128 v121, v[110:113] offset:16384
    ds_write_b128 v122, v[114:117] offset:16384
    ds_write_b64 v123, v[118:119] offset:16384
    buffer_load_dwordx2 v[62:63], v129, s[16:19], s37 offen offset:768 nt
    s_mov_b64 vcc, 1
    s_cmp_eq_u32 s32, 0
    s_cbranch_scc1 L_pad0
    s_cmp_eq_u32 s32, 1
    s_cbranch_scc1 L_pad1
    s_cmp_eq_u32 s32, 2
    s_cbranch_scc1 L_pad2
    s_cmp_eq_u32 s32, 3
    s_cbranch_scc1 L_pad3
L_padret0:
    s_mov_b64 vcc, 0
    s_waitcnt vmcnt(15)
    v_lshlrev_b32 v144, 16, v92
    v_and_b32 v145, s33, v92
    v_lshlrev_b32 v146, 16, v93
    v_and_b32 v147, s33, v93
    v_mov_b32_dpp v136, v144 row_newbcast:0 row_mask:0xf bank_mask:0xf
    v_lshlrev_b32 v148, 16, v94
    v_and_b32 v149, s33, v94
    v_pk_add_f32 v[144:145], v[144:145], v[136:137] op_sel_hi:[1,0] neg_lo:[0,1] neg_hi:[0,1]
    v_lshlrev_b32 v150, 16, v95
    v_and_b32 v151, s33, v95
    v_pk_add_f32 v[146:147], v[146:147], v[136:137] op_sel_hi:[1,0] neg_lo:[0,1] neg_hi:[0,1]
    v_pk_mul_f32 v[134:135], v[144:145], v[144:145]
    s_waitcnt vmcnt(14)
    v_lshlrev_b32 v152, 16, v96
    v_and_b32 v153, s33, v96
    v_pk_add_f32 v[148:149], v[148:149], v[136:137] op_sel_hi:[1,0] neg_lo:[0,1] neg_hi:[0,1]
    v_pk_add_f32 v[132:133], v[144:145], v[146:147]
    v_pk_fma_f32 v[134:135], v[146:147], v[146:147], v[134:135]
    v_lshlrev_b32 v154, 16, v97
    v_and_b32 v155, s33, v97
    v_pk_add_f32 v[150:151], v[150:151], v[136:137] op_sel_hi:[1,0] neg_lo:[0,1] neg_hi:[0,1]
    v_pk_add_f32 v[132:133], v[132:133], v[148:149]
    v_pk_fma_f32 v[134:135], v[148:149], v[148:149], v[134:135]
    v_lshlrev_b32 v156, 16, v98
    v_and_b32 v157, s33, v98
    v_pk_add_f32 v[152:153], v[152:153], v[136:137] op_sel_hi:[1,0] neg_lo:[0,1] neg_hi:[0,1]
    v_pk_add_f32 v[132:133], v[132:133], v[150:151]
    v_pk_fma_f32 v[134:135], v[150:151], v[150:151], v[134:135]
    v_lshlrev_b32 v158, 16, v99
    v_and_b32 v159, s33, v99
    v_pk_add_f32 v[154:155], v[154:155], v[136:137] op_sel_hi:[1,0] neg_lo:[0,1] neg_hi:[0,1]
    v_pk_add_f32 v[132:133], v[132:133], v[152:153]
    v_pk_fma_f32 v[134:135], v[152:153], v[152:153], v[134:135]
    s_waitcnt vmcnt(13)
    v_lshlrev_b32 v160, 16, v100
    v_and_b32 v161, s33, v100
    v_pk_add_f32 v[156:157], v[156:157], v[136:137] op_sel_hi:[1,0] neg_lo:[0,1] neg_hi:[0,1]
    v_pk_add_f32 v[132:133], v[132:133], v[154:155]
    v_pk_fma_f32 v[134:135], v[154:155], v[154:155], v[134:135]
    v_lshlrev_b32 v162, 16, v101
    v_and_b32 v163, s33, v101
    v_pk_add_f32 v[158:159], v[158:159], v[136:137] op_sel_hi:[1,0] neg_lo:[0,1] neg_hi:[0,1]
    v_pk_add_f32 v[132:133], v[132:133], v[156:157]
    v_pk_fma_f32 v[134:135], v[156:157], v[156:157], v[134:135]
    v_lshlrev_b32 v164, 16, v102
    v_and_b32 v165, s33, v102
    v_pk_add_f32 v[160:161], v[160:161], v[136:137] op_sel_hi:[1,0] neg_lo:[0,1] neg_hi:[0,1]
    v_pk_add_f32 v[132:133], v[132:133], v[158:159]
    v_pk_fma_f32 v[134:135], v[158:159], v[158:159], v[134:135]
    v_lshlrev_b32 v166, 16, v103
    v_and_b32 v167, s33, v103
    v_pk_add_f32 v[162:163], v[162:163], v[136:137] op_sel_hi:[1,0] neg_lo:[0,1] neg_hi:[0,1]
    v_pk_add_f32 v[132:133], v[132:133], v[160:161]
    v_pk_fma_f32 v[134:135], v[160:161], v[160:161], v[134:135]
    s_waitcnt vmcnt(12)
    v_lshlrev_b32 v168, 16, v104
    v_and_b32 v169, s33, v104
    v_pk_add_f32 v[164:165], v[164:165], v[136:137] op_sel_hi:[1,0] neg_lo:[0,1] neg_hi:[0,1]
    v_pk_add_f32 v[132:133], v[132:133], v[162:163]
    v_pk_fma_f32 v[134:135], v[162:163], v[162:163], v[134:135]
    v_lshlrev_b32 v170, 16, v105
    v_and_b32 v171, s33, v105
    v_pk_add_f32 v[166:167], v[166:167], v[136:137] op_sel_hi:[1,0] neg_lo:[0,1] neg_hi:[0,1]
    v_pk_add_f32 v[132:133], v[132:133], v[164:165]
    v_pk_fma_f32 v[134:135], v[164:165], v[164:165], v[134:135]
    v_pk_add_f32 v[168:169], v[168:169], v[136:137] op_sel_hi:[1,0] neg_lo:[0,1] neg_hi:[0,1]
    v_pk_add_f32 v[132:133], v[132:133], v[166:167]
    v_pk_fma_f32 v[134:135], v[166:167], v[166:167], v[134:135]
    v_pk_add_f32 v[170:171], v[170:171], v[136:137] op_sel_hi:[1,0] neg_lo:[0,1] neg_hi:[0,1]
    v_pk_add_f32 v[132:133], v[132:133], v[168:169]
    v_pk_fma_f32 v[134:135], v[168:169], v[168:169], v[134:135]
    v_pk_add_f32 v[132:133], v[132:133], v[170:171]
    v_pk_fma_f32 v[134:135], v[170:171], v[170:171], v[134:135]
    v_add_f32 v132, v132, v133
    v_add_f32 v134, v134, v135
    s_add_u32 s37, s37, 3584
    buffer_load_dwordx4 v[36:39], v128, s[16:19], s37 offen offset:0 nt
    v_add_f32_dpp v132, v132, v132 row_ror:8 row_mask:0xf bank_mask:0xf
    v_add_f32_dpp v134, v134, v134 row_ror:8 row_mask:0xf bank_mask:0xf
    s_nop 0
    v_add_f32_dpp v132, v132, v132 row_ror:4 row_mask:0xf bank_mask:0xf
    v_add_f32_dpp v134, v134, v134 row_ror:4 row_mask:0xf bank_mask:0xf
    s_nop 0
    v_add_f32_dpp v132, v132, v132 row_ror:2 row_mask:0xf bank_mask:0xf
    v_add_f32_dpp v134, v134, v134 row_ror:2 row_mask:0xf bank_mask:0xf
    buffer_load_dwordx4 v[40:43], v128, s[16:19], s37 offen offset:256 nt
    v_add_f32_dpp v132, v132, v132 row_ror:1 row_mask:0xf bank_mask:0xf
    v_add_f32_dpp v134, v134, v134 row_ror:1 row_mask:0xf bank_mask:0xf
    v_mul_f32 v132, s44, v132
    v_mul_f32 v134, s44, v134
    v_add_f32 v133, v136, v132
    v_fma_f32 v134, -v132, v132, v134
    v_cvt_pk_bf16_f32 v133, v133, v133
    v_max_f32 v134, 0, v134
    v_and_b32 v133, s33, v133
    v_add_f32 v134, v127, v134
    v_rsq_f32 v135, v134
    v_sub_f32 v133, v136, v133
    v_mul_f32 v133, v133, v135
    v_pk_fma_f32 v[144:145], v[144:145], v[134:135], v[132:133] op_sel:[0,1,1] op_sel_hi:[1,1,1]
    v_pk_fma_f32 v[146:147], v[146:147], v[134:135], v[132:133] op_sel:[0,1,1] op_sel_hi:[1,1,1]
    v_pk_fma_f32 v[148:149], v[148:149], v[134:135], v[132:133] op_sel:[0,1,1] op_sel_hi:[1,1,1]
    v_pk_fma_f32 v[150:151], v[150:151], v[134:135], v[132:133] op_sel:[0,1,1] op_sel_hi:[1,1,1]
    v_pk_fma_f32 v[144:145], v[144:145], v[172:173], v[200:201]
    v_pk_fma_f32 v[146:147], v[146:147], v[174:175], v[202:203]
    v_pk_fma_f32 v[148:149], v[148:149], v[176:177], v[204:205]
    v_pk_fma_f32 v[150:151], v[150:151], v[178:179], v[206:207]
    v_cvt_pk_bf16_f32 v92, v144, v145
    v_cvt_pk_bf16_f32 v93, v146, v147
    v_cvt_pk_bf16_f32 v94, v148, v149
    v_cvt_pk_bf16_f32 v95, v150, v151
    v_pk_fma_f32 v[152:153], v[152:153], v[134:135], v[132:133] op_sel:[0,1,1] op_sel_hi:[1,1,1]
    v_pk_fma_f32 v[154:155], v[154:155], v[134:135], v[132:133] op_sel:[0,1,1] op_sel_hi:[1,1,1]
    v_pk_fma_f32 v[156:157], v[156:157], v[134:135], v[132:133] op_sel:[0,1,1] op_sel_hi:[1,1,1]
    v_pk_fma_f32 v[158:159], v[158:159], v[134:135], v[132:133] op_sel:[0,1,1] op_sel_hi:[1,1,1]
    v_pk_fma_f32 v[152:153], v[152:153], v[180:181], v[208:209]
    v_pk_fma_f32 v[154:155], v[154:155], v[182:183], v[210:211]
    v_pk_fma_f32 v[156:157], v[156:157], v[184:185], v[212:213]
    v_pk_fma_f32 v[158:159], v[158:159], v[186:187], v[214:215]
    buffer_load_dwordx4 v[44:47], v128, s[16:19], s37 offen offset:512 nt
    v_cvt_pk_bf16_f32 v96, v152, v153
    v_cvt_pk_bf16_f32 v97, v154, v155
    v_cvt_pk_bf16_f32 v98, v156, v157
    v_cvt_pk_bf16_f32 v99, v158, v159
    v_pk_fma_f32 v[160:161], v[160:161], v[134:135], v[132:133] op_sel:[0,1,1] op_sel_hi:[1,1,1]
    v_pk_fma_f32 v[162:163], v[162:163], v[134:135], v[132:133] op_sel:[0,1,1] op_sel_hi:[1,1,1]
    v_pk_fma_f32 v[164:165], v[164:165], v[134:135], v[132:133] op_sel:[0,1,1] op_sel_hi:[1,1,1]
    v_pk_fma_f32 v[166:167], v[166:167], v[134:135], v[132:133] op_sel:[0,1,1] op_sel_hi:[1,1,1]
    v_pk_fma_f32 v[160:161], v[160:161], v[188:189], v[216:217]
    v_pk_fma_f32 v[162:163], v[162:163], v[190:191], v[218:219]
    v_pk_fma_f32 v[164:165], v[164:165], v[192:193], v[220:221]
    v_pk_fma_f32 v[166:167], v[166:167], v[194:195], v[222:223]
    v_cvt_pk_bf16_f32 v100, v160, v161
    v_cvt_pk_bf16_f32 v101, v162, v163
    v_cvt_pk_bf16_f32 v102, v164, v165
    v_cvt_pk_bf16_f32 v103, v166, v167
    v_pk_fma_f32 v[168:169], v[168:169], v[134:135], v[132:133] op_sel:[0,1,1] op_sel_hi:[1,1,1]
    v_pk_fma_f32 v[170:171], v[170:171], v[134:135], v[132:133] op_sel:[0,1,1] op_sel_hi:[1,1,1]
    v_pk_fma_f32 v[168:169], v[168:169], v[196:197], v[224:225]
    v_pk_fma_f32 v[170:171], v[170:171], v[198:199], v[226:227]
    v_cvt_pk_bf16_f32 v104, v168, v169
    v_cvt_pk_bf16_f32 v105, v170, v171
    ds_write_b128 v120, v[92:95] offset:16640
    ds_write_b128 v121, v[96:99] offset:16640
    ds_write_b128 v122, v[100:103] offset:16640
    ds_write_b64 v123, v[104:105] offset:16640
    buffer_load_dwordx2 v[48:49], v129, s[16:19], s37 offen offset:768 nt
    s_waitcnt vmcnt(15)
    v_lshlrev_b32 v144, 16, v78
    v_and_b32 v145, s33, v78
    v_lshlrev_b32 v146, 16, v79
    v_and_b32 v147, s33, v79
    v_mov_b32_dpp v136, v144 row_newbcast:0 row_mask:0xf bank_mask:0xf
    v_lshlrev_b32 v148, 16, v80
    v_and_b32 v149, s33, v80
    v_pk_add_f32 v[144:145], v[144:145], v[136:137] op_sel_hi:[1,0] neg_lo:[0,1] neg_hi:[0,1]
    v_lshlrev_b32 v150, 16, v81
    v_and_b32 v151, s33, v81
    v_pk_add_f32 v[146:147], v[146:147], v[136:137] op_sel_hi:[1,0] neg_lo:[0,1] neg_hi:[0,1]
    v_pk_mul_f32 v[134:135], v[144:145], v[144:145]
    s_waitcnt vmcnt(14)
    v_lshlrev_b32 v152, 16, v82
    v_and_b32 v153, s33, v82
    v_pk_add_f32 v[148:149], v[148:149], v[136:137] op_sel_hi:[1,0] neg_lo:[0,1] neg_hi:[0,1]
    v_pk_add_f32 v[132:133], v[144:145], v[146:147]
    v_pk_fma_f32 v[134:135], v[146:147], v[146:147], v[134:135]
    v_lshlrev_b32 v154, 16, v83
    v_and_b32 v155, s33, v83
    v_pk_add_f32 v[150:151], v[150:151], v[136:137] op_sel_hi:[1,0] neg_lo:[0,1] neg_hi:[0,1]
    v_pk_add_f32 v[132:133], v[132:133], v[148:149]
    v_pk_fma_f32 v[134:135], v[148:149], v[148:149], v[134:135]
    v_lshlrev_b32 v156, 16, v84
    v_and_b32 v157, s33, v84
    v_pk_add_f32 v[152:153], v[152:153], v[136:137] op_sel_hi:[1,0] neg_lo:[0,1] neg_hi:[0,1]
    v_pk_add_f32 v[132:133], v[132:133], v[150:151]
    v_pk_fma_f32 v[134:135], v[150:151], v[150:151], v[134:135]
    v_lshlrev_b32 v158, 16, v85
    v_and_b32 v159, s33, v85
    v_pk_add_f32 v[154:155], v[154:155], v[136:137] op_sel_hi:[1,0] neg_lo:[0,1] neg_hi:[0,1]
    v_pk_add_f32 v[132:133], v[132:133], v[152:153]
    v_pk_fma_f32 v[134:135], v[152:153], v[152:153], v[134:135]
    s_waitcnt vmcnt(13)
    v_lshlrev_b32 v160, 16, v86
    v_and_b32 v161, s33, v86
    v_pk_add_f32 v[156:157], v[156:157], v[136:137] op_sel_hi:[1,0] neg_lo:[0,1] neg_hi:[0,1]
    v_pk_add_f32 v[132:133], v[132:133], v[154:155]
    v_pk_fma_f32 v[134:135], v[154:155], v[154:155], v[134:135]
    v_lshlrev_b32 v162, 16, v87
    v_and_b32 v163, s33, v87
    v_pk_add_f32 v[158:159], v[158:159], v[136:137] op_sel_hi:[1,0] neg_lo:[0,1] neg_hi:[0,1]
    v_pk_add_f32 v[132:133], v[132:133], v[156:157]
    v_pk_fma_f32 v[134:135], v[156:157], v[156:157], v[134:135]
    v_lshlrev_b32 v164, 16, v88
    v_and_b32 v165, s33, v88
    v_pk_add_f32 v[160:161], v[160:161], v[136:137] op_sel_hi:[1,0] neg_lo:[0,1] neg_hi:[0,1]
    v_pk_add_f32 v[132:133], v[132:133], v[158:159]
    v_pk_fma_f32 v[134:135], v[158:159], v[158:159], v[134:135]
    v_lshlrev_b32 v166, 16, v89
    v_and_b32 v167, s33, v89
    v_pk_add_f32 v[162:163], v[162:163], v[136:137] op_sel_hi:[1,0] neg_lo:[0,1] neg_hi:[0,1]
    v_pk_add_f32 v[132:133], v[132:133], v[160:161]
    v_pk_fma_f32 v[134:135], v[160:161], v[160:161], v[134:135]
    s_waitcnt vmcnt(12)
    v_lshlrev_b32 v168, 16, v90
    v_and_b32 v169, s33, v90
    v_pk_add_f32 v[164:165], v[164:165], v[136:137] op_sel_hi:[1,0] neg_lo:[0,1] neg_hi:[0,1]
    v_pk_add_f32 v[132:133], v[132:133], v[162:163]
    v_pk_fma_f32 v[134:135], v[162:163], v[162:163], v[134:135]
    v_lshlrev_b32 v170, 16, v91
    v_and_b32 v171, s33, v91
    v_pk_add_f32 v[166:167], v[166:167], v[136:137] op_sel_hi:[1,0] neg_lo:[0,1] neg_hi:[0,1]
    v_pk_add_f32 v[132:133], v[132:133], v[164:165]
    v_pk_fma_f32 v[134:135], v[164:165], v[164:165], v[134:135]
    v_pk_add_f32 v[168:169], v[168:169], v[136:137] op_sel_hi:[1,0] neg_lo:[0,1] neg_hi:[0,1]
    v_pk_add_f32 v[132:133], v[132:133], v[166:167]
    v_pk_fma_f32 v[134:135], v[166:167], v[166:167], v[134:135]
    v_pk_add_f32 v[170:171], v[170:171], v[136:137] op_sel_hi:[1,0] neg_lo:[0,1] neg_hi:[0,1]
    v_pk_add_f32 v[132:133], v[132:133], v[168:169]
    v_pk_fma_f32 v[134:135], v[168:169], v[168:169], v[134:135]
    v_pk_add_f32 v[132:133], v[132:133], v[170:171]
    v_pk_fma_f32 v[134:135], v[170:171], v[170:171], v[134:135]
    v_add_f32 v132, v132, v133
    v_add_f32 v134, v134, v135
    s_nop 0
    v_add_f32_dpp v132, v132, v132 row_ror:8 row_mask:0xf bank_mask:0xf
    v_add_f32_dpp v134, v134, v134 row_ror:8 row_mask:0xf bank_mask:0xf
    s_nop 0
    v_add_f32_dpp v132, v132, v132 row_ror:4 row_mask:0xf bank_mask:0xf
    v_add_f32_dpp v134, v134, v134 row_ror:4 row_mask:0xf bank_mask:0xf
    s_add_u32 m0, s36, 0
    s_nop 0
    buffer_load_dwordx4 v16, s[24:27], s34 offen offset:0 lds
    v_add_f32_dpp v132, v132, v132 row_ror:2 row_mask:0xf bank_mask:0xf
    v_add_f32_dpp v134, v134, v134 row_ror:2 row_mask:0xf bank_mask:0xf
    s_nop 0
    v_add_f32_dpp v132, v132, v132 row_ror:1 row_mask:0xf bank_mask:0xf
    v_add_f32_dpp v134, v134, v134 row_ror:1 row_mask:0xf bank_mask:0xf
    v_mul_f32 v132, s44, v132
    v_mul_f32 v134, s44, v134
    v_add_f32 v133, v136, v132
    v_fma_f32 v134, -v132, v132, v134
    v_cvt_pk_bf16_f32 v133, v133, v133
    v_max_f32 v134, 0, v134
    v_and_b32 v133, s33, v133
    v_add_f32 v134, v127, v134
    v_rsq_f32 v135, v134
    v_sub_f32 v133, v136, v133
    v_mul_f32 v133, v133, v135
    v_pk_fma_f32 v[144:145], v[144:145], v[134:135], v[132:133] op_sel:[0,1,1] op_sel_hi:[1,1,1]
    v_pk_fma_f32 v[146:147], v[146:147], v[134:135], v[132:133] op_sel:[0,1,1] op_sel_hi:[1,1,1]
    v_pk_fma_f32 v[148:149], v[148:149], v[134:135], v[132:133] op_sel:[0,1,1] op_sel_hi:[1,1,1]
    v_pk_fma_f32 v[150:151], v[150:151], v[134:135], v[132:133] op_sel:[0,1,1] op_sel_hi:[1,1,1]
    v_pk_fma_f32 v[144:145], v[144:145], v[172:173], v[200:201]
    v_pk_fma_f32 v[146:147], v[146:147], v[174:175], v[202:203]
    v_pk_fma_f32 v[148:149], v[148:149], v[176:177], v[204:205]
    v_pk_fma_f32 v[150:151], v[150:151], v[178:179], v[206:207]
    v_cvt_pk_bf16_f32 v78, v144, v145
    v_cvt_pk_bf16_f32 v79, v146, v147
    v_cvt_pk_bf16_f32 v80, v148, v149
    v_cvt_pk_bf16_f32 v81, v150, v151
    v_pk_fma_f32 v[152:153], v[152:153], v[134:135], v[132:133] op_sel:[0,1,1] op_sel_hi:[1,1,1]
    v_pk_fma_f32 v[154:155], v[154:155], v[134:135], v[132:133] op_sel:[0,1,1] op_sel_hi:[1,1,1]
    v_pk_fma_f32 v[156:157], v[156:157], v[134:135], v[132:133] op_sel:[0,1,1] op_sel_hi:[1,1,1]
    v_pk_fma_f32 v[158:159], v[158:159], v[134:135], v[132:133] op_sel:[0,1,1] op_sel_hi:[1,1,1]
    v_pk_fma_f32 v[152:153], v[152:153], v[180:181], v[208:209]
    v_pk_fma_f32 v[154:155], v[154:155], v[182:183], v[210:211]
    v_pk_fma_f32 v[156:157], v[156:157], v[184:185], v[212:213]
    v_pk_fma_f32 v[158:159], v[158:159], v[186:187], v[214:215]
    v_cvt_pk_bf16_f32 v82, v152, v153
    v_cvt_pk_bf16_f32 v83, v154, v155
    v_cvt_pk_bf16_f32 v84, v156, v157
    v_cvt_pk_bf16_f32 v85, v158, v159
    v_pk_fma_f32 v[160:161], v[160:161], v[134:135], v[132:133] op_sel:[0,1,1] op_sel_hi:[1,1,1]
    v_pk_fma_f32 v[162:163], v[162:163], v[134:135], v[132:133] op_sel:[0,1,1] op_sel_hi:[1,1,1]
    v_pk_fma_f32 v[164:165], v[164:165], v[134:135], v[132:133] op_sel:[0,1,1] op_sel_hi:[1,1,1]
    v_pk_fma_f32 v[166:167], v[166:167], v[134:135], v[132:133] op_sel:[0,1,1] op_sel_hi:[1,1,1]
    v_pk_fma_f32 v[160:161], v[160:161], v[188:189], v[216:217]
    v_pk_fma_f32 v[162:163], v[162:163], v[190:191], v[218:219]
    v_pk_fma_f32 v[164:165], v[164:165], v[192:193], v[220:221]
    v_pk_fma_f32 v[166:167], v[166:167], v[194:195], v[222:223]
    v_cvt_pk_bf16_f32 v86, v160, v161
    v_cvt_pk_bf16_f32 v87, v162, v163
    v_cvt_pk_bf16_f32 v88, v164, v165
    v_cvt_pk_bf16_f32 v89, v166, v167
    v_pk_fma_f32 v[168:169], v[168:169], v[134:135], v[132:133] op_sel:[0,1,1] op_sel_hi:[1,1,1]
    v_pk_fma_f32 v[170:171], v[170:171], v[134:135], v[132:133] op_sel:[0,1,1] op_sel_hi:[1,1,1]
    v_pk_fma_f32 v[168:169], v[168:169], v[196:197], v[224:225]
    v_pk_fma_f32 v[170:171], v[170:171], v[198:199], v[226:227]
    v_cvt_pk_bf16_f32 v90, v168, v169
    v_cvt_pk_bf16_f32 v91, v170, v171
    ds_write_b128 v1, v[78:81] offset:30208
    ds_write_b128 v2, v[82:85] offset:30208
    ds_write_b128 v3, v[86:89] offset:30208
    ds_write_b64 v4, v[90:91] offset:30208
    buffer_load_dwordx4 v17, s[24:27], s34 offen offset:1024 lds
    s_waitcnt vmcnt(13)
    v_lshlrev_b32 v144, 16, v64
    v_and_b32 v145, s33, v64
    v_lshlrev_b32 v146, 16, v65
    v_and_b32 v147, s33, v65
    v_mov_b32_dpp v136, v144 row_newbcast:0 row_mask:0xf bank_mask:0xf
    v_lshlrev_b32 v148, 16, v66
    v_and_b32 v149, s33, v66
    v_pk_add_f32 v[144:145], v[144:145], v[136:137] op_sel_hi:[1,0] neg_lo:[0,1] neg_hi:[0,1]
    v_lshlrev_b32 v150, 16, v67
    v_and_b32 v151, s33, v67
    v_pk_add_f32 v[146:147], v[146:147], v[136:137] op_sel_hi:[1,0] neg_lo:[0,1] neg_hi:[0,1]
    v_pk_mul_f32 v[134:135], v[144:145], v[144:145]
    s_waitcnt vmcnt(12)
    v_lshlrev_b32 v152, 16, v68
    v_and_b32 v153, s33, v68
    v_pk_add_f32 v[148:149], v[148:149], v[136:137] op_sel_hi:[1,0] neg_lo:[0,1] neg_hi:[0,1]
    v_pk_add_f32 v[132:133], v[144:145], v[146:147]
    v_pk_fma_f32 v[134:135], v[146:147], v[146:147], v[134:135]
    v_lshlrev_b32 v154, 16, v69
    v_and_b32 v155, s33, v69
    v_pk_add_f32 v[150:151], v[150:151], v[136:137] op_sel_hi:[1,0] neg_lo:[0,1] neg_hi:[0,1]
    v_pk_add_f32 v[132:133], v[132:133], v[148:149]
    v_pk_fma_f32 v[134:135], v[148:149], v[148:149], v[134:135]
    v_lshlrev_b32 v156, 16, v70
    v_and_b32 v157, s33, v70
    v_pk_add_f32 v[152:153], v[152:153], v[136:137] op_sel_hi:[1,0] neg_lo:[0,1] neg_hi:[0,1]
    v_pk_add_f32 v[132:133], v[132:133], v[150:151]
    v_pk_fma_f32 v[134:135], v[150:151], v[150:151], v[134:135]
    v_lshlrev_b32 v158, 16, v71
    v_and_b32 v159, s33, v71
    v_pk_add_f32 v[154:155], v[154:155], v[136:137] op_sel_hi:[1,0] neg_lo:[0,1] neg_hi:[0,1]
    v_pk_add_f32 v[132:133], v[132:133], v[152:153]
    v_pk_fma_f32 v[134:135], v[152:153], v[152:153], v[134:135]
    s_waitcnt vmcnt(11)
    v_lshlrev_b32 v160, 16, v72
    v_and_b32 v161, s33, v72
    v_pk_add_f32 v[156:157], v[156:157], v[136:137] op_sel_hi:[1,0] neg_lo:[0,1] neg_hi:[0,1]
    v_pk_add_f32 v[132:133], v[132:133], v[154:155]
    v_pk_fma_f32 v[134:135], v[154:155], v[154:155], v[134:135]
    v_lshlrev_b32 v162, 16, v73
    v_and_b32 v163, s33, v73
    v_pk_add_f32 v[158:159], v[158:159], v[136:137] op_sel_hi:[1,0] neg_lo:[0,1] neg_hi:[0,1]
    v_pk_add_f32 v[132:133], v[132:133], v[156:157]
    v_pk_fma_f32 v[134:135], v[156:157], v[156:157], v[134:135]
    v_lshlrev_b32 v164, 16, v74
    v_and_b32 v165, s33, v74
    v_pk_add_f32 v[160:161], v[160:161], v[136:137] op_sel_hi:[1,0] neg_lo:[0,1] neg_hi:[0,1]
    v_pk_add_f32 v[132:133], v[132:133], v[158:159]
    v_pk_fma_f32 v[134:135], v[158:159], v[158:159], v[134:135]
    v_lshlrev_b32 v166, 16, v75
    v_and_b32 v167, s33, v75
    v_pk_add_f32 v[162:163], v[162:163], v[136:137] op_sel_hi:[1,0] neg_lo:[0,1] neg_hi:[0,1]
    v_pk_add_f32 v[132:133], v[132:133], v[160:161]
    v_pk_fma_f32 v[134:135], v[160:161], v[160:161], v[134:135]
    s_waitcnt vmcnt(10)
    v_lshlrev_b32 v168, 16, v76
    v_and_b32 v169, s33, v76
    v_pk_add_f32 v[164:165], v[164:165], v[136:137] op_sel_hi:[1,0] neg_lo:[0,1] neg_hi:[0,1]
    v_pk_add_f32 v[132:133], v[132:133], v[162:163]
    v_pk_fma_f32 v[134:135], v[162:163], v[162:163], v[134:135]
    v_lshlrev_b32 v170, 16, v77
    v_and_b32 v171, s33, v77
    v_pk_add_f32 v[166:167], v[166:167], v[136:137] op_sel_hi:[1,0] neg_lo:[0,1] neg_hi:[0,1]
    v_pk_add_f32 v[132:133], v[132:133], v[164:165]
    v_pk_fma_f32 v[134:135], v[164:165], v[164:165], v[134:135]
    v_pk_add_f32 v[168:169], v[168:169], v[136:137] op_sel_hi:[1,0] neg_lo:[0,1] neg_hi:[0,1]
    v_pk_add_f32 v[132:133], v[132:133], v[166:167]
    v_pk_fma_f32 v[134:135], v[166:167], v[166:167], v[134:135]
    v_pk_add_f32 v[170:171], v[170:171], v[136:137] op_sel_hi:[1,0] neg_lo:[0,1] neg_hi:[0,1]
    v_pk_add_f32 v[132:133], v[132:133], v[168:169]
    v_pk_fma_f32 v[134:135], v[168:169], v[168:169], v[134:135]
    v_pk_add_f32 v[132:133], v[132:133], v[170:171]
    v_pk_fma_f32 v[134:135], v[170:171], v[170:171], v[134:135]
    v_add_f32 v132, v132, v133
    v_add_f32 v134, v134, v135
    s_nop 0
    v_add_f32_dpp v132, v132, v132 row_ror:8 row_mask:0xf bank_mask:0xf
    v_add_f32_dpp v134, v134, v134 row_ror:8 row_mask:0xf bank_mask:0xf
    s_nop 0
    v_add_f32_dpp v132, v132, v132 row_ror:4 row_mask:0xf bank_mask:0xf
    v_add_f32_dpp v134, v134, v134 row_ror:4 row_mask:0xf bank_mask:0xf
    buffer_load_dwordx4 v18, s[24:27], s34 offen offset:2048 lds
    v_add_f32_dpp v132, v132, v132 row_ror:2 row_mask:0xf bank_mask:0xf
    v_add_f32_dpp v134, v134, v134 row_ror:2 row_mask:0xf bank_mask:0xf
    s_nop 0
    v_add_f32_dpp v132, v132, v132 row_ror:1 row_mask:0xf bank_mask:0xf
    v_add_f32_dpp v134, v134, v134 row_ror:1 row_mask:0xf bank_mask:0xf
    v_mul_f32 v132, s44, v132
    v_mul_f32 v134, s44, v134
    v_add_f32 v133, v136, v132
    v_fma_f32 v134, -v132, v132, v134
    v_cvt_pk_bf16_f32 v133, v133, v133
    v_max_f32 v134, 0, v134
    v_and_b32 v133, s33, v133
    v_add_f32 v134, v127, v134
    v_rsq_f32 v135, v134
    v_sub_f32 v133, v136, v133
    v_mul_f32 v133, v133, v135
    v_pk_fma_f32 v[144:145], v[144:145], v[134:135], v[132:133] op_sel:[0,1,1] op_sel_hi:[1,1,1]
    v_pk_fma_f32 v[146:147], v[146:147], v[134:135], v[132:133] op_sel:[0,1,1] op_sel_hi:[1,1,1]
    v_pk_fma_f32 v[148:149], v[148:149], v[134:135], v[132:133] op_sel:[0,1,1] op_sel_hi:[1,1,1]
    v_pk_fma_f32 v[150:151], v[150:151], v[134:135], v[132:133] op_sel:[0,1,1] op_sel_hi:[1,1,1]
    v_pk_fma_f32 v[144:145], v[144:145], v[172:173], v[200:201]
    v_pk_fma_f32 v[146:147], v[146:147], v[174:175], v[202:203]
    v_pk_fma_f32 v[148:149], v[148:149], v[176:177], v[204:205]
    v_pk_fma_f32 v[150:151], v[150:151], v[178:179], v[206:207]
    v_cvt_pk_bf16_f32 v64, v144, v145
    v_cvt_pk_bf16_f32 v65, v146, v147
    v_cvt_pk_bf16_f32 v66, v148, v149
    v_cvt_pk_bf16_f32 v67, v150, v151
    v_pk_fma_f32 v[152:153], v[152:153], v[134:135], v[132:133] op_sel:[0,1,1] op_sel_hi:[1,1,1]
    v_pk_fma_f32 v[154:155], v[154:155], v[134:135], v[132:133] op_sel:[0,1,1] op_sel_hi:[1,1,1]
    v_pk_fma_f32 v[156:157], v[156:157], v[134:135], v[132:133] op_sel:[0,1,1] op_sel_hi:[1,1,1]
    v_pk_fma_f32 v[158:159], v[158:159], v[134:135], v[132:133] op_sel:[0,1,1] op_sel_hi:[1,1,1]
    v_pk_fma_f32 v[152:153], v[152:153], v[180:181], v[208:209]
    v_pk_fma_f32 v[154:155], v[154:155], v[182:183], v[210:211]
    v_pk_fma_f32 v[156:157], v[156:157], v[184:185], v[212:213]
    v_pk_fma_f32 v[158:159], v[158:159], v[186:187], v[214:215]
    v_cvt_pk_bf16_f32 v68, v152, v153
    v_cvt_pk_bf16_f32 v69, v154, v155
    v_cvt_pk_bf16_f32 v70, v156, v157
    v_cvt_pk_bf16_f32 v71, v158, v159
    v_pk_fma_f32 v[160:161], v[160:161], v[134:135], v[132:133] op_sel:[0,1,1] op_sel_hi:[1,1,1]
    v_pk_fma_f32 v[162:163], v[162:163], v[134:135], v[132:133] op_sel:[0,1,1] op_sel_hi:[1,1,1]
    v_pk_fma_f32 v[164:165], v[164:165], v[134:135], v[132:133] op_sel:[0,1,1] op_sel_hi:[1,1,1]
    v_pk_fma_f32 v[166:167], v[166:167], v[134:135], v[132:133] op_sel:[0,1,1] op_sel_hi:[1,1,1]
    v_pk_fma_f32 v[160:161], v[160:161], v[188:189], v[216:217]
    v_pk_fma_f32 v[162:163], v[162:163], v[190:191], v[218:219]
    v_pk_fma_f32 v[164:165], v[164:165], v[192:193], v[220:221]
    v_pk_fma_f32 v[166:167], v[166:167], v[194:195], v[222:223]
    v_cvt_pk_bf16_f32 v72, v160, v161
    v_cvt_pk_bf16_f32 v73, v162, v163
    v_cvt_pk_bf16_f32 v74, v164, v165
    v_cvt_pk_bf16_f32 v75, v166, v167
    v_pk_fma_f32 v[168:169], v[168:169], v[134:135], v[132:133] op_sel:[0,1,1] op_sel_hi:[1,1,1]
    v_pk_fma_f32 v[170:171], v[170:171], v[134:135], v[132:133] op_sel:[0,1,1] op_sel_hi:[1,1,1]
    v_pk_fma_f32 v[168:169], v[168:169], v[196:197], v[224:225]
    v_pk_fma_f32 v[170:171], v[170:171], v[198:199], v[226:227]
    v_cvt_pk_bf16_f32 v76, v168, v169
    v_cvt_pk_bf16_f32 v77, v170, v171
    ds_write_b128 v1, v[64:67] offset:33792
    ds_write_b128 v2, v[68:71] offset:33792
    ds_write_b128 v3, v[72:75] offset:33792
    ds_write_b64 v4, v[76:77] offset:33792
    s_add_u32 m0, s36, 3072
    s_nop 0
    buffer_load_dwordx4 v19, s[24:27], s34 offen offset:0 lds
    s_waitcnt vmcnt(11)
    v_lshlrev_b32 v144, 16, v50
    v_and_b32 v145, s33, v50
    v_lshlrev_b32 v146, 16, v51
    v_and_b32 v147, s33, v51
    v_mov_b32_dpp v136, v144 row_newbcast:0 row_mask:0xf bank_mask:0xf
    v_lshlrev_b32 v148, 16, v52
    v_and_b32 v149, s33, v52
    v_pk_add_f32 v[144:145], v[144:145], v[136:137] op_sel_hi:[1,0] neg_lo:[0,1] neg_hi:[0,1]
    v_lshlrev_b32 v150, 16, v53
    v_and_b32 v151, s33, v53
    v_pk_add_f32 v[146:147], v[146:147], v[136:137] op_sel_hi:[1,0] neg_lo:[0,1] neg_hi:[0,1]
L_pad0:
    s_cbranch_vccnz L_padret0
    v_pk_mul_f32 v[134:135], v[144:145], v[144:145]
    s_waitcnt vmcnt(10)
    v_lshlrev_b32 v152, 16, v54
    v_and_b32 v153, s33, v54
    v_pk_add_f32 v[148:149], v[148:149], v[136:137] op_sel_hi:[1,0] neg_lo:[0,1] neg_hi:[0,1]
    v_pk_add_f32 v[132:133], v[144:145], v[146:147]
    v_pk_fma_f32 v[134:135], v[146:147], v[146:147], v[134:135]
    v_lshlrev_b32 v154, 16, v55
    v_and_b32 v155, s33, v55
    v_pk_add_f32 v[150:151], v[150:151], v[136:137] op_sel_hi:[1,0] neg_lo:[0,1] neg_hi:[0,1]
    v_pk_add_f32 v[132:133], v[132:133], v[148:149]
    v_pk_fma_f32 v[134:135], v[148:149], v[148:149], v[134:135]
    v_lshlrev_b32 v156, 16, v56
    v_and_b32 v157, s33, v56
    v_pk_add_f32 v[152:153], v[152:153], v[136:137] op_sel_hi:[1,0] neg_lo:[0,1] neg_hi:[0,1]
    v_pk_add_f32 v[132:133], v[132:133], v[150:151]
    v_pk_fma_f32 v[134:135], v[150:151], v[150:151], v[134:135]
    v_lshlrev_b32 v158, 16, v57
    v_and_b32 v159, s33, v57
    v_pk_add_f32 v[154:155], v[154:155], v[136:137] op_sel_hi:[1,0] neg_lo:[0,1] neg_hi:[0,1]
    v_pk_add_f32 v[132:133], v[132:133], v[152:153]
    v_pk_fma_f32 v[134:135], v[152:153], v[152:153], v[134:135]
    s_waitcnt vmcnt(9)
    v_lshlrev_b32 v160, 16, v58
    v_and_b32 v161, s33, v58
    v_pk_add_f32 v[156:157], v[156:157], v[136:137] op_sel_hi:[1,0] neg_lo:[0,1] neg_hi:[0,1]
    v_pk_add_f32 v[132:133], v[132:133], v[154:155]
    v_pk_fma_f32 v[134:135], v[154:155], v[154:155], v[134:135]
    v_lshlrev_b32 v162, 16, v59
    v_and_b32 v163, s33, v59
    v_pk_add_f32 v[158:159], v[158:159], v[136:137] op_sel_hi:[1,0] neg_lo:[0,1] neg_hi:[0,1]
    v_pk_add_f32 v[132:133], v[132:133], v[156:157]
    v_pk_fma_f32 v[134:135], v[156:157], v[156:157], v[134:135]
    v_lshlrev_b32 v164, 16, v60
    v_and_b32 v165, s33, v60
    v_pk_add_f32 v[160:161], v[160:161], v[136:137] op_sel_hi:[1,0] neg_lo:[0,1] neg_hi:[0,1]
    v_pk_add_f32 v[132:133], v[132:133], v[158:159]
    v_pk_fma_f32 v[134:135], v[158:159], v[158:159], v[134:135]
    v_lshlrev_b32 v166, 16, v61
    v_and_b32 v167, s33, v61
    v_pk_add_f32 v[162:163], v[162:163], v[136:137] op_sel_hi:[1,0] neg_lo:[0,1] neg_hi:[0,1]
    v_pk_add_f32 v[132:133], v[132:133], v[160:161]
    v_pk_fma_f32 v[134:135], v[160:161], v[160:161], v[134:135]
    s_waitcnt vmcnt(8)
    v_lshlrev_b32 v168, 16, v62
    v_and_b32 v169, s33, v62
    v_pk_add_f32 v[164:165], v[164:165], v[136:137] op_sel_hi:[1,0] neg_lo:[0,1] neg_hi:[0,1]
    v_pk_add_f32 v[132:133], v[132:133], v[162:163]
    v_pk_fma_f32 v[134:135], v[162:163], v[162:163], v[134:135]
    v_lshlrev_b32 v170, 16, v63
    v_and_b32 v171, s33, v63
    v_pk_add_f32 v[166:167], v[166:167], v[136:137] op_sel_hi:[1,0] neg_lo:[0,1] neg_hi:[0,1]
    v_pk_add_f32 v[132:133], v[132:133], v[164:165]
    v_pk_fma_f32 v[134:135], v[164:165], v[164:165], v[134:135]
    v_pk_add_f32 v[168:169], v[168:169], v[136:137] op_sel_hi:[1,0] neg_lo:[0,1] neg_hi:[0,1]
    v_pk_add_f32 v[132:133], v[132:133], v[166:167]
    v_pk_fma_f32 v[134:135], v[166:167], v[166:167], v[134:135]
    v_pk_add_f32 v[170:171], v[170:171], v[136:137] op_sel_hi:[1,0] neg_lo:[0,1] neg_hi:[0,1]
    v_pk_add_f32 v[132:133], v[132:133], v[168:169]
    v_pk_fma_f32 v[134:135], v[168:169], v[168:169], v[134:135]
    v_pk_add_f32 v[132:133], v[132:133], v[170:171]
    v_pk_fma_f32 v[134:135], v[170:171], v[170:171], v[134:135]
    v_add_f32 v132, v132, v133
    v_add_f32 v134, v134, v135
    buffer_load_dwordx4 v20, s[24:27], s34 offen offset:1024 lds
    v_add_f32_dpp v132, v132, v132 row_ror:8 row_mask:0xf bank_mask:0xf
    v_add_f32_dpp v134, v134, v134 row_ror:8 row_mask:0xf bank_mask:0xf
    s_nop 0
    v_add_f32_dpp v132, v132, v132 row_ror:4 row_mask:0xf bank_mask:0xf
    v_add_f32_dpp v134, v134, v134 row_ror:4 row_mask:0xf bank_mask:0xf
    s_nop 0
    v_add_f32_dpp v132, v132, v132 row_ror:2 row_mask:0xf bank_mask:0xf
    v_add_f32_dpp v134, v134, v134 row_ror:2 row_mask:0xf bank_mask:0xf
    s_nop 0
    v_add_f32_dpp v132, v132, v132 row_ror:1 row_mask:0xf bank_mask:0xf
    v_add_f32_dpp v134, v134, v134 row_ror:1 row_mask:0xf bank_mask:0xf
    v_mul_f32 v132, s44, v132
    v_mul_f32 v134, s44, v134
    v_add_f32 v133, v136, v132
    v_fma_f32 v134, -v132, v132, v134
    v_cvt_pk_bf16_f32 v133, v133, v133
    v_max_f32 v134, 0, v134
    v_and_b32 v133, s33, v133
    v_add_f32 v134, v127, v134
    v_rsq_f32 v135, v134
    v_sub_f32 v133, v136, v133
    v_mul_f32 v133, v133, v135
    v_pk_fma_f32 v[144:145], v[144:145], v[134:135], v[132:133] op_sel:[0,1,1] op_sel_hi:[1,1,1]
    v_pk_fma_f32 v[146:147], v[146:147], v[134:135], v[132:133] op_sel:[0,1,1] op_sel_hi:[1,1,1]
    v_pk_fma_f32 v[148:149], v[148:149], v[134:135], v[132:133] op_sel:[0,1,1] op_sel_hi:[1,1,1]
    v_pk_fma_f32 v[150:151], v[150:151], v[134:135], v[132:133] op_sel:[0,1,1] op_sel_hi:[1,1,1]
    v_pk_fma_f32 v[144:145], v[144:145], v[172:173], v[200:201]
    v_pk_fma_f32 v[146:147], v[146:147], v[174:175], v[202:203]
    v_pk_fma_f32 v[148:149], v[148:149], v[176:177], v[204:205]
    v_pk_fma_f32 v[150:151], v[150:151], v[178:179], v[206:207]
    v_cvt_pk_bf16_f32 v50, v144, v145
    v_cvt_pk_bf16_f32 v51, v146, v147
    v_cvt_pk_bf16_f32 v52, v148, v149
    v_cvt_pk_bf16_f32 v53, v150, v151
    v_pk_fma_f32 v[152:153], v[152:153], v[134:135], v[132:133] op_sel:[0,1,1] op_sel_hi:[1,1,1]
    buffer_load_dwordx4 v21, s[24:27], s34 offen offset:2048 lds
    v_pk_fma_f32 v[154:155], v[154:155], v[134:135], v[132:133] op_sel:[0,1,1] op_sel_hi:[1,1,1]
    v_pk_fma_f32 v[156:157], v[156:157], v[134:135], v[132:133] op_sel:[0,1,1] op_sel_hi:[1,1,1]
    v_pk_fma_f32 v[158:159], v[158:159], v[134:135], v[132:133] op_sel:[0,1,1] op_sel_hi:[1,1,1]
    v_pk_fma_f32 v[152:153], v[152:153], v[180:181], v[208:209]
    v_pk_fma_f32 v[154:155], v[154:155], v[182:183], v[210:211]
    v_pk_fma_f32 v[156:157], v[156:157], v[184:185], v[212:213]
    v_pk_fma_f32 v[158:159], v[158:159], v[186:187], v[214:215]
    v_cvt_pk_bf16_f32 v54, v152, v153
    v_cvt_pk_bf16_f32 v55, v154, v155
    v_cvt_pk_bf16_f32 v56, v156, v157
    v_cvt_pk_bf16_f32 v57, v158, v159
    v_pk_fma_f32 v[160:161], v[160:161], v[134:135], v[132:133] op_sel:[0,1,1] op_sel_hi:[1,1,1]
    v_pk_fma_f32 v[162:163], v[162:163], v[134:135], v[132:133] op_sel:[0,1,1] op_sel_hi:[1,1,1]
    v_pk_fma_f32 v[164:165], v[164:165], v[134:135], v[132:133] op_sel:[0,1,1] op_sel_hi:[1,1,1]
    v_pk_fma_f32 v[166:167], v[166:167], v[134:135], v[132:133] op_sel:[0,1,1] op_sel_hi:[1,1,1]
    v_pk_fma_f32 v[160:161], v[160:161], v[188:189], v[216:217]
    v_pk_fma_f32 v[162:163], v[162:163], v[190:191], v[218:219]
    v_pk_fma_f32 v[164:165], v[164:165], v[192:193], v[220:221]
    v_pk_fma_f32 v[166:167], v[166:167], v[194:195], v[222:223]
    v_cvt_pk_bf16_f32 v58, v160, v161
    v_cvt_pk_bf16_f32 v59, v162, v163
    v_cvt_pk_bf16_f32 v60, v164, v165
    v_cvt_pk_bf16_f32 v61, v166, v167
    v_pk_fma_f32 v[168:169], v[168:169], v[134:135], v[132:133] op_sel:[0,1,1] op_sel_hi:[1,1,1]
    v_pk_fma_f32 v[170:171], v[170:171], v[134:135], v[132:133] op_sel:[0,1,1] op_sel_hi:[1,1,1]
    v_pk_fma_f32 v[168:169], v[168:169], v[196:197], v[224:225]
    v_pk_fma_f32 v[170:171], v[170:171], v[198:199], v[226:227]
    v_cvt_pk_bf16_f32 v62, v168, v169
    v_cvt_pk_bf16_f32 v63, v170, v171
    ds_write_b128 v1, v[50:53] offset:37376
    ds_write_b128 v2, v[54:57] offset:37376
    ds_write_b128 v3, v[58:61] offset:37376
    ds_write_b64 v4, v[62:63] offset:37376
    buffer_load_dwordx4 v22, s[24:27], s34 offen offset:3072 lds
    s_waitcnt vmcnt(10)
    v_lshlrev_b32 v144, 16, v36
    v_and_b32 v145, s33, v36
    v_lshlrev_b32 v146, 16, v37
    v_and_b32 v147, s33, v37
    v_mov_b32_dpp v136, v144 row_newbcast:0 row_mask:0xf bank_mask:0xf
    v_lshlrev_b32 v148, 16, v38
    v_and_b32 v149, s33, v38
    v_pk_add_f32 v[144:145], v[144:145], v[136:137] op_sel_hi:[1,0] neg_lo:[0,1] neg_hi:[0,1]
    v_lshlrev_b32 v150, 16, v39
    v_and_b32 v151, s33, v39
    v_pk_add_f32 v[146:147], v[146:147], v[136:137] op_sel_hi:[1,0] neg_lo:[0,1] neg_hi:[0,1]
    v_pk_mul_f32 v[134:135], v[144:145], v[144:145]
    s_waitcnt vmcnt(9)
    v_lshlrev_b32 v152, 16, v40
    v_and_b32 v153, s33, v40
    s_add_u32 m0, s36, 7168
    s_add_u32 s34, s34, 28672
    s_cmp_ge_u32 s34, s35
    s_cselect_b32 s34, s45, s34
    buffer_load_dwordx4 v16, s[24:27], s34 offen offset:0 lds
    v_pk_add_f32 v[148:149], v[148:149], v[136:137] op_sel_hi:[1,0] neg_lo:[0,1] neg_hi:[0,1]
    v_pk_add_f32 v[132:133], v[144:145], v[146:147]
    v_pk_fma_f32 v[134:135], v[146:147], v[146:147], v[134:135]
    v_lshlrev_b32 v154, 16, v41
    v_and_b32 v155, s33, v41
    v_pk_add_f32 v[150:151], v[150:151], v[136:137] op_sel_hi:[1,0] neg_lo:[0,1] neg_hi:[0,1]
    v_pk_add_f32 v[132:133], v[132:133], v[148:149]
    v_pk_fma_f32 v[134:135], v[148:149], v[148:149], v[134:135]
    v_lshlrev_b32 v156, 16, v42
    v_and_b32 v157, s33, v42
    v_pk_add_f32 v[152:153], v[152:153], v[136:137] op_sel_hi:[1,0] neg_lo:[0,1] neg_hi:[0,1]
    v_pk_add_f32 v[132:133], v[132:133], v[150:151]
    v_pk_fma_f32 v[134:135], v[150:151], v[150:151], v[134:135]
    v_lshlrev_b32 v158, 16, v43
    v_and_b32 v159, s33, v43
    v_pk_add_f32 v[154:155], v[154:155], v[136:137] op_sel_hi:[1,0] neg_lo:[0,1] neg_hi:[0,1]
    v_pk_add_f32 v[132:133], v[132:133], v[152:153]
    buffer_load_dwordx4 v17, s[24:27], s34 offen offset:1024 lds
    v_pk_fma_f32 v[134:135], v[152:153], v[152:153], v[134:135]
    s_waitcnt vmcnt(10)
    v_lshlrev_b32 v160, 16, v44
    v_and_b32 v161, s33, v44
    v_pk_add_f32 v[156:157], v[156:157], v[136:137] op_sel_hi:[1,0] neg_lo:[0,1] neg_hi:[0,1]
    v_pk_add_f32 v[132:133], v[132:133], v[154:155]
    v_pk_fma_f32 v[134:135], v[154:155], v[154:155], v[134:135]
    v_lshlrev_b32 v162, 16, v45
    v_and_b32 v163, s33, v45
    v_pk_add_f32 v[158:159], v[158:159], v[136:137] op_sel_hi:[1,0] neg_lo:[0,1] neg_hi:[0,1]
    v_pk_add_f32 v[132:133], v[132:133], v[156:157]
    v_pk_fma_f32 v[134:135], v[156:157], v[156:157], v[134:135]
    v_lshlrev_b32 v164, 16, v46
    v_and_b32 v165, s33, v46
    v_pk_add_f32 v[160:161], v[160:161], v[136:137] op_sel_hi:[1,0] neg_lo:[0,1] neg_hi:[0,1]
    v_pk_add_f32 v[132:133], v[132:133], v[158:159]
    v_pk_fma_f32 v[134:135], v[158:159], v[158:159], v[134:135]
    buffer_load_dwordx4 v18, s[24:27], s34 offen offset:2048 lds
    v_lshlrev_b32 v166, 16, v47
    v_and_b32 v167, s33, v47
    v_pk_add_f32 v[162:163], v[162:163], v[136:137] op_sel_hi:[1,0] neg_lo:[0,1] neg_hi:[0,1]
    v_pk_add_f32 v[132:133], v[132:133], v[160:161]
    v_pk_fma_f32 v[134:135], v[160:161], v[160:161], v[134:135]
    s_waitcnt vmcnt(10)
    v_lshlrev_b32 v168, 16, v48
    v_and_b32 v169, s33, v48
    v_pk_add_f32 v[164:165], v[164:165], v[136:137] op_sel_hi:[1,0] neg_lo:[0,1] neg_hi:[0,1]
    v_pk_add_f32 v[132:133], v[132:133], v[162:163]
    v_pk_fma_f32 v[134:135], v[162:163], v[162:163], v[134:135]
    v_lshlrev_b32 v170, 16, v49
    v_and_b32 v171, s33, v49
    v_pk_add_f32 v[166:167], v[166:167], v[136:137] op_sel_hi:[1,0] neg_lo:[0,1] neg_hi:[0,1]
    s_add_u32 m0, s36, 10240
    s_nop 0
    buffer_load_dwordx4 v19, s[24:27], s34 offen offset:0 lds
    v_pk_add_f32 v[132:133], v[132:133], v[164:165]
    v_pk_fma_f32 v[134:135], v[164:165], v[164:165], v[134:135]
    v_pk_add_f32 v[168:169], v[168:169], v[136:137] op_sel_hi:[1,0] neg_lo:[0,1] neg_hi:[0,1]
    v_pk_add_f32 v[132:133], v[132:133], v[166:167]
    v_pk_fma_f32 v[134:135], v[166:167], v[166:167], v[134:135]
    v_pk_add_f32 v[170:171], v[170:171], v[136:137] op_sel_hi:[1,0] neg_lo:[0,1] neg_hi:[0,1]
    v_pk_add_f32 v[132:133], v[132:133], v[168:169]
    v_pk_fma_f32 v[134:135], v[168:169], v[168:169], v[134:135]
    v_pk_add_f32 v[132:133], v[132:133], v[170:171]
    v_pk_fma_f32 v[134:135], v[170:171], v[170:171], v[134:135]
    v_add_f32 v132, v132, v133
    v_add_f32 v134, v134, v135
    buffer_load_dwordx4 v20, s[24:27], s34 offen offset:1024 lds
    v_add_f32_dpp v132, v132, v132 row_ror:8 row_mask:0xf bank_mask:0xf
    v_add_f32_dpp v134, v134, v134 row_ror:8 row_mask:0xf bank_mask:0xf
    s_nop 0
    v_add_f32_dpp v132, v132, v132 row_ror:4 row_mask:0xf bank_mask:0xf
    v_add_f32_dpp v134, v134, v134 row_ror:4 row_mask:0xf bank_mask:0xf
    s_nop 0
    v_add_f32_dpp v132, v132, v132 row_ror:2 row_mask:0xf bank_mask:0xf
    v_add_f32_dpp v134, v134, v134 row_ror:2 row_mask:0xf bank_mask:0xf
    buffer_load_dwordx4 v21, s[24:27], s34 offen offset:2048 lds
    v_add_f32_dpp v132, v132, v132 row_ror:1 row_mask:0xf bank_mask:0xf
    v_add_f32_dpp v134, v134, v134 row_ror:1 row_mask:0xf bank_mask:0xf
    v_mul_f32 v132, s44, v132
    v_mul_f32 v134, s44, v134
    v_add_f32 v133, v136, v132
    v_fma_f32 v134, -v132, v132, v134
    v_cvt_pk_bf16_f32 v133, v133, v133
    s_waitcnt vmcnt(9)
    ds_read_b64_tr_b16 a[0:1], v5 offset:0
    ds_read_b64_tr_b16 a[4:5], v5 offset:8
    ds_read_b64_tr_b16 a[8:9], v5 offset:64
    ds_read_b64_tr_b16 a[12:13], v5 offset:72
    ds_read_b64_tr_b16 a[16:17], v5 offset:128
    ds_read_b64_tr_b16 a[20:21], v5 offset:136
    ds_read_b64_tr_b16 a[24:25], v23 offset:0
    v_max_f32 v134, 0, v134
    v_and_b32 v133, s33, v133
    v_add_f32 v134, v127, v134
    v_rsq_f32 v135, v134
    v_sub_f32 v133, v136, v133
    v_mul_f32 v133, v133, v135
    v_pk_fma_f32 v[144:145], v[144:145], v[134:135], v[132:133] op_sel:[0,1,1] op_sel_hi:[1,1,1]
    v_pk_fma_f32 v[146:147], v[146:147], v[134:135], v[132:133] op_sel:[0,1,1] op_sel_hi:[1,1,1]
    v_pk_fma_f32 v[148:149], v[148:149], v[134:135], v[132:133] op_sel:[0,1,1] op_sel_hi:[1,1,1]
    v_pk_fma_f32 v[150:151], v[150:151], v[134:135], v[132:133] op_sel:[0,1,1] op_sel_hi:[1,1,1]
    v_pk_fma_f32 v[144:145], v[144:145], v[172:173], v[200:201]
    buffer_load_dwordx4 v22, s[24:27], s34 offen offset:3072 lds
    v_pk_fma_f32 v[146:147], v[146:147], v[174:175], v[202:203]
    v_pk_fma_f32 v[148:149], v[148:149], v[176:177], v[204:205]
    v_pk_fma_f32 v[150:151], v[150:151], v[178:179], v[206:207]
    v_cvt_pk_bf16_f32 v24, v144, v145
    v_cvt_pk_bf16_f32 v25, v146, v147
    v_cvt_pk_bf16_f32 v26, v148, v149
    v_cvt_pk_bf16_f32 v27, v150, v151
    v_pk_fma_f32 v[152:153], v[152:153], v[134:135], v[132:133] op_sel:[0,1,1] op_sel_hi:[1,1,1]
    s_add_u32 m0, s36, 0
    s_add_u32 s34, s34, 28672
    s_cmp_ge_u32 s34, s35
    s_cselect_b32 s34, s45, s34
    s_waitcnt lgkmcnt(0)
    buffer_load_dwordx4 v16, s[24:27], s34 offen offset:0 lds
    v_pk_fma_f32 v[154:155], v[154:155], v[134:135], v[132:133] op_sel:[0,1,1] op_sel_hi:[1,1,1]
    v_pk_fma_f32 v[156:157], v[156:157], v[134:135], v[132:133] op_sel:[0,1,1] op_sel_hi:[1,1,1]
    v_pk_fma_f32 v[158:159], v[158:159], v[134:135], v[132:133] op_sel:[0,1,1] op_sel_hi:[1,1,1]
    v_pk_fma_f32 v[152:153], v[152:153], v[180:181], v[208:209]
    v_pk_fma_f32 v[154:155], v[154:155], v[182:183], v[210:211]
    v_pk_fma_f32 v[156:157], v[156:157], v[184:185], v[212:213]
    v_pk_fma_f32 v[158:159], v[158:159], v[186:187], v[214:215]
    v_cvt_pk_bf16_f32 v28, v152, v153
    v_cvt_pk_bf16_f32 v29, v154, v155
    buffer_load_dwordx4 v17, s[24:27], s34 offen offset:1024 lds
    v_cvt_pk_bf16_f32 v30, v156, v157
    v_cvt_pk_bf16_f32 v31, v158, v159
    v_pk_fma_f32 v[160:161], v[160:161], v[134:135], v[132:133] op_sel:[0,1,1] op_sel_hi:[1,1,1]
    v_pk_fma_f32 v[162:163], v[162:163], v[134:135], v[132:133] op_sel:[0,1,1] op_sel_hi:[1,1,1]
    v_pk_fma_f32 v[164:165], v[164:165], v[134:135], v[132:133] op_sel:[0,1,1] op_sel_hi:[1,1,1]
    s_waitcnt vmcnt(9)
    ds_read_b64_tr_b16 a[2:3], v5 offset:3584
    ds_read_b64_tr_b16 a[6:7], v5 offset:3592
    ds_read_b64_tr_b16 a[10:11], v5 offset:3648
    ds_read_b64_tr_b16 a[14:15], v5 offset:3656
    ds_read_b64_tr_b16 a[18:19], v5 offset:3712
    ds_read_b64_tr_b16 a[22:23], v5 offset:3720
    ds_read_b64_tr_b16 a[26:27], v23 offset:3584
    v_pk_fma_f32 v[166:167], v[166:167], v[134:135], v[132:133] op_sel:[0,1,1] op_sel_hi:[1,1,1]
    v_pk_fma_f32 v[160:161], v[160:161], v[188:189], v[216:217]
    v_pk_fma_f32 v[162:163], v[162:163], v[190:191], v[218:219]
    v_pk_fma_f32 v[164:165], v[164:165], v[192:193], v[220:221]
    v_pk_fma_f32 v[166:167], v[166:167], v[194:195], v[222:223]
    v_cvt_pk_bf16_f32 v32, v160, v161
    v_cvt_pk_bf16_f32 v33, v162, v163
    v_cvt_pk_bf16_f32 v34, v164, v165
    v_cvt_pk_bf16_f32 v35, v166, v167
    v_pk_fma_f32 v[168:169], v[168:169], v[134:135], v[132:133] op_sel:[0,1,1] op_sel_hi:[1,1,1]
    buffer_load_dwordx4 v18, s[24:27], s34 offen offset:2048 lds
    v_pk_fma_f32 v[170:171], v[170:171], v[134:135], v[132:133] op_sel:[0,1,1] op_sel_hi:[1,1,1]
    v_pk_fma_f32 v[168:169], v[168:169], v[196:197], v[224:225]
    v_pk_fma_f32 v[170:171], v[170:171], v[198:199], v[226:227]
    v_cvt_pk_bf16_f32 v6, v168, v169
    v_cvt_pk_bf16_f32 v7, v170, v171
    s_waitcnt lgkmcnt(0)
    s_barrier
    ds_read_b128 v[8:11], v0 offset:16640
    s_waitcnt lgkmcnt(0)
    s_add_u32 m0, s36, 3072
    s_nop 0
    v_mfma_f32_16x16x32_bf16 v[228:231], a[0:3], v[8:11], 0
    ds_read_b128 v[12:15], v0 offset:15872
    v_mfma_f32_16x16x32_bf16 v[232:235], a[4:7], v[8:11], 0
    buffer_load_dwordx4 v19, s[24:27], s34 offen offset:0 lds
    v_mfma_f32_16x16x32_bf16 v[236:239], a[8:11], v[8:11], 0
    buffer_load_dwordx4 v20, s[24:27], s34 offen offset:1024 lds
    v_mfma_f32_16x16x32_bf16 v[240:243], a[12:15], v[8:11], 0
    buffer_load_dwordx4 v21, s[24:27], s34 offen offset:2048 lds
    v_mfma_f32_16x16x32_bf16 v[244:247], a[16:19], v[8:11], 0
    buffer_load_dwordx4 v22, s[24:27], s34 offen offset:3072 lds
    v_mfma_f32_16x16x32_bf16 v[248:251], a[20:23], v[8:11], 0
    s_waitcnt vmcnt(10)
    ds_read_b64_tr_b16 a[28:29], v5 offset:7168
    v_mfma_f32_16x16x32_bf16 v[252:255], a[24:27], v[8:11], 0
    s_waitcnt lgkmcnt(1)
    ds_read_b64_tr_b16 a[32:33], v5 offset:7176
    v_mfma_f32_16x16x32_bf16 v[36:39], a[0:3], v[12:15], 0
    ds_read_b128 v[8:11], v0 offset:16128
    v_mfma_f32_16x16x32_bf16 v[40:43], a[4:7], v[12:15], 0
    ds_read_b64_tr_b16 a[36:37], v5 offset:7232
    v_mfma_f32_16x16x32_bf16 v[44:47], a[8:11], v[12:15], 0
    ds_read_b64_tr_b16 a[40:41], v5 offset:7240
    v_mfma_f32_16x16x32_bf16 v[48:51], a[12:15], v[12:15], 0
    ds_read_b64_tr_b16 a[44:45], v5 offset:7296
    v_mfma_f32_16x16x32_bf16 v[52:55], a[16:19], v[12:15], 0
    ds_read_b64_tr_b16 a[48:49], v5 offset:7304
    v_mfma_f32_16x16x32_bf16 v[56:59], a[20:23], v[12:15], 0
    ds_read_b64_tr_b16 a[52:53], v23 offset:7168
    v_mfma_f32_16x16x32_bf16 v[60:63], a[24:27], v[12:15], 0
    s_waitcnt lgkmcnt(5)
    s_add_u32 m0, s36, 7168
    s_add_u32 s34, s34, 28672
    v_mfma_f32_16x16x32_bf16 v[64:67], a[0:3], v[8:11], 0
    ds_read_b128 v[12:15], v0 offset:16384
    s_cmp_ge_u32 s34, s35
    v_mfma_f32_16x16x32_bf16 v[68:71], a[4:7], v[8:11], 0
    s_waitcnt lgkmcnt(1)
    s_cselect_b32 s34, s45, s34
    v_mfma_f32_16x16x32_bf16 v[72:75], a[8:11], v[8:11], 0
    buffer_load_dwordx4 v16, s[24:27], s34 offen offset:0 lds
    v_mfma_f32_16x16x32_bf16 v[76:79], a[12:15], v[8:11], 0
    buffer_load_dwordx4 v17, s[24:27], s34 offen offset:1024 lds
    v_mfma_f32_16x16x32_bf16 v[80:83], a[16:19], v[8:11], 0
    buffer_load_dwordx4 v18, s[24:27], s34 offen offset:2048 lds
    v_mfma_f32_16x16x32_bf16 v[84:87], a[20:23], v[8:11], 0
    s_waitcnt vmcnt(10)
    ds_read_b64_tr_b16 a[30:31], v5 offset:10752
    v_mfma_f32_16x16x32_bf16 v[88:91], a[24:27], v[8:11], 0
    s_waitcnt lgkmcnt(1)
    ds_read_b64_tr_b16 a[34:35], v5 offset:10760
    v_mfma_f32_16x16x32_bf16 v[92:95], a[0:3], v[12:15], 0
    ds_read_b128 v[8:11], v0 offset:17664
    ds_read_b64_tr_b16 a[38:39], v5 offset:10816
    v_mfma_f32_16x16x32_bf16 v[96:99], a[4:7], v[12:15], 0
    ds_read_b64_tr_b16 a[42:43], v5 offset:10824
    ds_read_b64_tr_b16 a[46:47], v5 offset:10880
    v_mfma_f32_16x16x32_bf16 v[100:103], a[8:11], v[12:15], 0
    ds_read_b64_tr_b16 a[50:51], v5 offset:10888
    v_mfma_f32_16x16x32_bf16 v[104:107], a[12:15], v[12:15], 0
    ds_read_b64_tr_b16 a[54:55], v23 offset:10752
    v_mfma_f32_16x16x32_bf16 v[108:111], a[16:19], v[12:15], 0
    s_add_u32 m0, s36, 10240
    v_mfma_f32_16x16x32_bf16 v[112:115], a[20:23], v[12:15], 0
    v_mfma_f32_16x16x32_bf16 v[116:119], a[24:27], v[12:15], 0
    s_waitcnt lgkmcnt(5)
    s_waitcnt lgkmcnt(0)
    v_mfma_f32_16x16x32_bf16 v[228:231], a[28:31], v[8:11], v[228:231]
    ds_read_b128 v[12:15], v0 offset:16896
    v_mfma_f32_16x16x32_bf16 v[232:235], a[32:35], v[8:11], v[232:235]
    buffer_load_dwordx4 v19, s[24:27], s34 offen offset:0 lds
    v_mfma_f32_16x16x32_bf16 v[236:239], a[36:39], v[8:11], v[236:239]
    buffer_load_dwordx4 v20, s[24:27], s34 offen offset:1024 lds
    v_mfma_f32_16x16x32_bf16 v[240:243], a[40:43], v[8:11], v[240:243]
    buffer_load_dwordx4 v21, s[24:27], s34 offen offset:2048 lds
    v_mfma_f32_16x16x32_bf16 v[244:247], a[44:47], v[8:11], v[244:247]
    buffer_load_dwordx4 v22, s[24:27], s34 offen offset:3072 lds
    v_mfma_f32_16x16x32_bf16 v[248:251], a[48:51], v[8:11], v[248:251]
    s_waitcnt vmcnt(10)
    ds_read_b64_tr_b16 a[56:57], v5 offset:0
    v_mfma_f32_16x16x32_bf16 v[252:255], a[52:55], v[8:11], v[252:255]
    s_waitcnt lgkmcnt(1)
    ds_read_b64_tr_b16 a[60:61], v5 offset:8
    v_mfma_f32_16x16x32_bf16 v[36:39], a[28:31], v[12:15], v[36:39]
    ds_read_b128 v[8:11], v0 offset:17152
    v_mfma_f32_16x16x32_bf16 v[40:43], a[32:35], v[12:15], v[40:43]
    ds_read_b64_tr_b16 a[64:65], v5 offset:64
    v_mfma_f32_16x16x32_bf16 v[44:47], a[36:39], v[12:15], v[44:47]
    ds_read_b64_tr_b16 a[68:69], v5 offset:72
    v_mfma_f32_16x16x32_bf16 v[48:51], a[40:43], v[12:15], v[48:51]
    ds_read_b64_tr_b16 a[72:73], v5 offset:128
    v_mfma_f32_16x16x32_bf16 v[52:55], a[44:47], v[12:15], v[52:55]
    ds_read_b64_tr_b16 a[76:77], v5 offset:136
    v_mfma_f32_16x16x32_bf16 v[56:59], a[48:51], v[12:15], v[56:59]
    ds_read_b64_tr_b16 a[80:81], v23 offset:0
    v_mfma_f32_16x16x32_bf16 v[60:63], a[52:55], v[12:15], v[60:63]
    s_waitcnt lgkmcnt(5)
    s_add_u32 m0, s36, 0
    s_add_u32 s34, s34, 28672
    v_mfma_f32_16x16x32_bf16 v[64:67], a[28:31], v[8:11], v[64:67]
    ds_read_b128 v[12:15], v0 offset:17408
    s_cmp_ge_u32 s34, s35
    v_mfma_f32_16x16x32_bf16 v[68:71], a[32:35], v[8:11], v[68:71]
    s_waitcnt lgkmcnt(1)
    s_cselect_b32 s34, s45, s34
    v_mfma_f32_16x16x32_bf16 v[72:75], a[36:39], v[8:11], v[72:75]
    buffer_load_dwordx4 v16, s[24:27], s34 offen offset:0 lds
    v_mfma_f32_16x16x32_bf16 v[76:79], a[40:43], v[8:11], v[76:79]
    buffer_load_dwordx4 v17, s[24:27], s34 offen offset:1024 lds
    v_mfma_f32_16x16x32_bf16 v[80:83], a[44:47], v[8:11], v[80:83]
    buffer_load_dwordx4 v18, s[24:27], s34 offen offset:2048 lds
    v_mfma_f32_16x16x32_bf16 v[84:87], a[48:51], v[8:11], v[84:87]
    s_waitcnt vmcnt(10)
    ds_read_b64_tr_b16 a[58:59], v5 offset:3584
    v_mfma_f32_16x16x32_bf16 v[88:91], a[52:55], v[8:11], v[88:91]
    s_waitcnt lgkmcnt(1)
    ds_read_b64_tr_b16 a[62:63], v5 offset:3592
    v_mfma_f32_16x16x32_bf16 v[92:95], a[28:31], v[12:15], v[92:95]
    ds_read_b128 v[8:11], v0 offset:18688
    ds_read_b64_tr_b16 a[66:67], v5 offset:3648
    v_mfma_f32_16x16x32_bf16 v[96:99], a[32:35], v[12:15], v[96:99]
    ds_read_b64_tr_b16 a[70:71], v5 offset:3656
    ds_read_b64_tr_b16 a[74:75], v5 offset:3712
    v_mfma_f32_16x16x32_bf16 v[100:103], a[36:39], v[12:15], v[100:103]
    ds_read_b64_tr_b16 a[78:79], v5 offset:3720
    v_mfma_f32_16x16x32_bf16 v[104:107], a[40:43], v[12:15], v[104:107]
    ds_read_b64_tr_b16 a[82:83], v23 offset:3584
    v_mfma_f32_16x16x32_bf16 v[108:111], a[44:47], v[12:15], v[108:111]
    s_add_u32 m0, s36, 3072
    v_mfma_f32_16x16x32_bf16 v[112:115], a[48:51], v[12:15], v[112:115]
    v_mfma_f32_16x16x32_bf16 v[116:119], a[52:55], v[12:15], v[116:119]
    s_waitcnt lgkmcnt(5)
    s_waitcnt lgkmcnt(0)
    v_mfma_f32_16x16x32_bf16 v[228:231], a[56:59], v[8:11], v[228:231]
    ds_read_b128 v[12:15], v0 offset:17920
    v_mfma_f32_16x16x32_bf16 v[232:235], a[60:63], v[8:11], v[232:235]
    buffer_load_dwordx4 v19, s[24:27], s34 offen offset:0 lds
    v_mfma_f32_16x16x32_bf16 v[236:239], a[64:67], v[8:11], v[236:239]
    buffer_load_dwordx4 v20, s[24:27], s34 offen offset:1024 lds
    v_mfma_f32_16x16x32_bf16 v[240:243], a[68:71], v[8:11], v[240:243]
    buffer_load_dwordx4 v21, s[24:27], s34 offen offset:2048 lds
    v_mfma_f32_16x16x32_bf16 v[244:247], a[72:75], v[8:11], v[244:247]
    buffer_load_dwordx4 v22, s[24:27], s34 offen offset:3072 lds
    v_mfma_f32_16x16x32_bf16 v[248:251], a[76:79], v[8:11], v[248:251]
    s_waitcnt vmcnt(10)
    ds_read_b64_tr_b16 a[84:85], v5 offset:7168
    v_mfma_f32_16x16x32_bf16 v[252:255], a[80:83], v[8:11], v[252:255]
    s_waitcnt lgkmcnt(1)
    ds_read_b64_tr_b16 a[88:89], v5 offset:7176
    v_mfma_f32_16x16x32_bf16 v[36:39], a[56:59], v[12:15], v[36:39]
    ds_read_b128 v[8:11], v0 offset:18176
    v_mfma_f32_16x16x32_bf16 v[40:43], a[60:63], v[12:15], v[40:43]
    ds_read_b64_tr_b16 a[92:93], v5 offset:7232
    v_mfma_f32_16x16x32_bf16 v[44:47], a[64:67], v[12:15], v[44:47]
    ds_read_b64_tr_b16 a[96:97], v5 offset:7240
    v_mfma_f32_16x16x32_bf16 v[48:51], a[68:71], v[12:15], v[48:51]
    ds_read_b64_tr_b16 a[100:101], v5 offset:7296
    v_mfma_f32_16x16x32_bf16 v[52:55], a[72:75], v[12:15], v[52:55]
    ds_read_b64_tr_b16 a[104:105], v5 offset:7304
    v_mfma_f32_16x16x32_bf16 v[56:59], a[76:79], v[12:15], v[56:59]
    ds_read_b64_tr_b16 a[108:109], v23 offset:7168
    v_mfma_f32_16x16x32_bf16 v[60:63], a[80:83], v[12:15], v[60:63]
    s_waitcnt lgkmcnt(5)
    s_add_u32 m0, s36, 7168
    s_add_u32 s34, s34, 28672
    v_mfma_f32_16x16x32_bf16 v[64:67], a[56:59], v[8:11], v[64:67]
    ds_read_b128 v[12:15], v0 offset:18432
    s_cmp_ge_u32 s34, s35
    v_mfma_f32_16x16x32_bf16 v[68:71], a[60:63], v[8:11], v[68:71]
    s_waitcnt lgkmcnt(1)
    s_cselect_b32 s34, s45, s34
    v_mfma_f32_16x16x32_bf16 v[72:75], a[64:67], v[8:11], v[72:75]
    buffer_load_dwordx4 v16, s[24:27], s34 offen offset:0 lds
    v_mfma_f32_16x16x32_bf16 v[76:79], a[68:71], v[8:11], v[76:79]
    buffer_load_dwordx4 v17, s[24:27], s34 offen offset:1024 lds
    v_mfma_f32_16x16x32_bf16 v[80:83], a[72:75], v[8:11], v[80:83]
    buffer_load_dwordx4 v18, s[24:27], s34 offen offset:2048 lds
    v_mfma_f32_16x16x32_bf16 v[84:87], a[76:79], v[8:11], v[84:87]
    s_waitcnt vmcnt(10)
    ds_read_b64_tr_b16 a[86:87], v5 offset:10752
    v_mfma_f32_16x16x32_bf16 v[88:91], a[80:83], v[8:11], v[88:91]
    s_waitcnt lgkmcnt(1)
    ds_read_b64_tr_b16 a[90:91], v5 offset:10760
    v_mfma_f32_16x16x32_bf16 v[92:95], a[56:59], v[12:15], v[92:95]
    ds_read_b128 v[8:11], v0 offset:19712
    ds_read_b64_tr_b16 a[94:95], v5 offset:10816
    v_mfma_f32_16x16x32_bf16 v[96:99], a[60:63], v[12:15], v[96:99]
    ds_read_b64_tr_b16 a[98:99], v5 offset:10824
    ds_read_b64_tr_b16 a[102:103], v5 offset:10880
    v_mfma_f32_16x16x32_bf16 v[100:103], a[64:67], v[12:15], v[100:103]
    ds_read_b64_tr_b16 a[106:107], v5 offset:10888
    v_mfma_f32_16x16x32_bf16 v[104:107], a[68:71], v[12:15], v[104:107]
    ds_read_b64_tr_b16 a[110:111], v23 offset:10752
    v_mfma_f32_16x16x32_bf16 v[108:111], a[72:75], v[12:15], v[108:111]
    s_add_u32 m0, s36, 10240
    v_mfma_f32_16x16x32_bf16 v[112:115], a[76:79], v[12:15], v[112:115]
    v_mfma_f32_16x16x32_bf16 v[116:119], a[80:83], v[12:15], v[116:119]
    s_waitcnt lgkmcnt(5)
    s_waitcnt lgkmcnt(0)
    v_mfma_f32_16x16x32_bf16 v[228:231], a[84:87], v[8:11], v[228:231]
    ds_read_b128 v[12:15], v0 offset:18944
    v_mfma_f32_16x16x32_bf16 v[232:235], a[88:91], v[8:11], v[232:235]
    buffer_load_dwordx4 v19, s[24:27], s34 offen offset:0 lds
    v_mfma_f32_16x16x32_bf16 v[236:239], a[92:95], v[8:11], v[236:239]
    buffer_load_dwordx4 v20, s[24:27], s34 offen offset:1024 lds
    v_mfma_f32_16x16x32_bf16 v[240:243], a[96:99], v[8:11], v[240:243]
    buffer_load_dwordx4 v21, s[24:27], s34 offen offset:2048 lds
    v_mfma_f32_16x16x32_bf16 v[244:247], a[100:103], v[8:11], v[244:247]
    buffer_load_dwordx4 v22, s[24:27], s34 offen offset:3072 lds
    v_mfma_f32_16x16x32_bf16 v[248:251], a[104:107], v[8:11], v[248:251]
    s_waitcnt vmcnt(10)
    ds_read_b64_tr_b16 a[112:113], v5 offset:0
    v_mfma_f32_16x16x32_bf16 v[252:255], a[108:111], v[8:11], v[252:255]
    s_waitcnt lgkmcnt(1)
    ds_read_b64_tr_b16 a[116:117], v5 offset:8
    v_mfma_f32_16x16x32_bf16 v[36:39], a[84:87], v[12:15], v[36:39]
    ds_read_b128 v[8:11], v0 offset:19200
    v_mfma_f32_16x16x32_bf16 v[40:43], a[88:91], v[12:15], v[40:43]
    ds_read_b64_tr_b16 a[120:121], v5 offset:64
    v_mfma_f32_16x16x32_bf16 v[44:47], a[92:95], v[12:15], v[44:47]
    ds_read_b64_tr_b16 a[124:125], v5 offset:72
    v_mfma_f32_16x16x32_bf16 v[48:51], a[96:99], v[12:15], v[48:51]
    ds_read_b64_tr_b16 a[128:129], v5 offset:128
    v_mfma_f32_16x16x32_bf16 v[52:55], a[100:103], v[12:15], v[52:55]
    ds_read_b64_tr_b16 a[132:133], v5 offset:136
    v_mfma_f32_16x16x32_bf16 v[56:59], a[104:107], v[12:15], v[56:59]
    ds_read_b64_tr_b16 a[136:137], v23 offset:0
    v_mfma_f32_16x16x32_bf16 v[60:63], a[108:111], v[12:15], v[60:63]
    s_waitcnt lgkmcnt(5)
    s_add_u32 m0, s36, 0
    s_add_u32 s34, s34, 28672
    v_mfma_f32_16x16x32_bf16 v[64:67], a[84:87], v[8:11], v[64:67]
    ds_read_b128 v[12:15], v0 offset:19456
    s_cmp_ge_u32 s34, s35
    v_mfma_f32_16x16x32_bf16 v[68:71], a[88:91], v[8:11], v[68:71]
    s_waitcnt lgkmcnt(1)
    s_cselect_b32 s34, s45, s34
    v_mfma_f32_16x16x32_bf16 v[72:75], a[92:95], v[8:11], v[72:75]
    buffer_load_dwordx4 v16, s[24:27], s34 offen offset:0 lds
    v_mfma_f32_16x16x32_bf16 v[76:79], a[96:99], v[8:11], v[76:79]
    buffer_load_dwordx4 v17, s[24:27], s34 offen offset:1024 lds
    v_mfma_f32_16x16x32_bf16 v[80:83], a[100:103], v[8:11], v[80:83]
    buffer_load_dwordx4 v18, s[24:27], s34 offen offset:2048 lds
    v_mfma_f32_16x16x32_bf16 v[84:87], a[104:107], v[8:11], v[84:87]
    s_waitcnt vmcnt(10)
    ds_read_b64_tr_b16 a[114:115], v5 offset:3584
    v_mfma_f32_16x16x32_bf16 v[88:91], a[108:111], v[8:11], v[88:91]
    s_waitcnt lgkmcnt(1)
    ds_read_b64_tr_b16 a[118:119], v5 offset:3592
    v_mfma_f32_16x16x32_bf16 v[92:95], a[84:87], v[12:15], v[92:95]
    ds_read_b128 v[8:11], v0 offset:20736
    ds_read_b64_tr_b16 a[122:123], v5 offset:3648
    v_mfma_f32_16x16x32_bf16 v[96:99], a[88:91], v[12:15], v[96:99]
    ds_read_b64_tr_b16 a[126:127], v5 offset:3656
    ds_read_b64_tr_b16 a[130:131], v5 offset:3712
    v_mfma_f32_16x16x32_bf16 v[100:103], a[92:95], v[12:15], v[100:103]
    ds_read_b64_tr_b16 a[134:135], v5 offset:3720
    v_mfma_f32_16x16x32_bf16 v[104:107], a[96:99], v[12:15], v[104:107]
    ds_read_b64_tr_b16 a[138:139], v23 offset:3584
    v_mfma_f32_16x16x32_bf16 v[108:111], a[100:103], v[12:15], v[108:111]
    s_add_u32 m0, s36, 3072
    v_mfma_f32_16x16x32_bf16 v[112:115], a[104:107], v[12:15], v[112:115]
    v_mfma_f32_16x16x32_bf16 v[116:119], a[108:111], v[12:15], v[116:119]
L_pad1:
    s_cbranch_vccnz L_padret0
    s_waitcnt lgkmcnt(5)
    s_waitcnt lgkmcnt(0)
    v_mfma_f32_16x16x32_bf16 v[228:231], a[112:115], v[8:11], v[228:231]
    ds_read_b128 v[12:15], v0 offset:19968
    v_mfma_f32_16x16x32_bf16 v[232:235], a[116:119], v[8:11], v[232:235]
    buffer_load_dwordx4 v19, s[24:27], s34 offen offset:0 lds
    v_mfma_f32_16x16x32_bf16 v[236:239], a[120:123], v[8:11], v[236:239]
    buffer_load_dwordx4 v20, s[24:27], s34 offen offset:1024 lds
    v_mfma_f32_16x16x32_bf16 v[240:243], a[124:127], v[8:11], v[240:243]
    buffer_load_dwordx4 v21, s[24:27], s34 offen offset:2048 lds
    v_mfma_f32_16x16x32_bf16 v[244:247], a[128:131], v[8:11], v[244:247]
    buffer_load_dwordx4 v22, s[24:27], s34 offen offset:3072 lds
    v_mfma_f32_16x16x32_bf16 v[248:251], a[132:135], v[8:11], v[248:251]
    s_waitcnt vmcnt(10)
    ds_read_b64_tr_b16 a[140:141], v5 offset:7168
    v_mfma_f32_16x16x32_bf16 v[252:255], a[136:139], v[8:11], v[252:255]
    s_waitcnt lgkmcnt(1)
    ds_read_b64_tr_b16 a[144:145], v5 offset:7176
    v_mfma_f32_16x16x32_bf16 v[36:39], a[112:115], v[12:15], v[36:39]
    ds_read_b128 v[8:11], v0 offset:20224
    v_mfma_f32_16x16x32_bf16 v[40:43], a[116:119], v[12:15], v[40:43]
    ds_read_b64_tr_b16 a[148:149], v5 offset:7232
    v_mfma_f32_16x16x32_bf16 v[44:47], a[120:123], v[12:15], v[44:47]
    ds_read_b64_tr_b16 a[152:153], v5 offset:7240
    v_mfma_f32_16x16x32_bf16 v[48:51], a[124:127], v[12:15], v[48:51]
    ds_read_b64_tr_b16 a[156:157], v5 offset:7296
    v_mfma_f32_16x16x32_bf16 v[52:55], a[128:131], v[12:15], v[52:55]
    ds_read_b64_tr_b16 a[160:161], v5 offset:7304
    v_mfma_f32_16x16x32_bf16 v[56:59], a[132:135], v[12:15], v[56:59]
    ds_read_b64_tr_b16 a[164:165], v23 offset:7168
    v_mfma_f32_16x16x32_bf16 v[60:63], a[136:139], v[12:15], v[60:63]
    s_waitcnt lgkmcnt(5)
    s_add_u32 m0, s36, 7168
    s_add_u32 s34, s34, 28672
    v_mfma_f32_16x16x32_bf16 v[64:67], a[112:115], v[8:11], v[64:67]
    ds_read_b128 v[12:15], v0 offset:20480
    s_cmp_ge_u32 s34, s35
    v_mfma_f32_16x16x32_bf16 v[68:71], a[116:119], v[8:11], v[68:71]
    s_waitcnt lgkmcnt(1)
    s_cselect_b32 s34, s45, s34
    v_mfma_f32_16x16x32_bf16 v[72:75], a[120:123], v[8:11], v[72:75]
    buffer_load_dwordx4 v16, s[24:27], s34 offen offset:0 lds
    v_mfma_f32_16x16x32_bf16 v[76:79], a[124:127], v[8:11], v[76:79]
    buffer_load_dwordx4 v17, s[24:27], s34 offen offset:1024 lds
    v_mfma_f32_16x16x32_bf16 v[80:83], a[128:131], v[8:11], v[80:83]
    buffer_load_dwordx4 v18, s[24:27], s34 offen offset:2048 lds
    v_mfma_f32_16x16x32_bf16 v[84:87], a[132:135], v[8:11], v[84:87]
    s_waitcnt vmcnt(10)
    ds_read_b64_tr_b16 a[142:143], v5 offset:10752
    v_mfma_f32_16x16x32_bf16 v[88:91], a[136:139], v[8:11], v[88:91]
    s_waitcnt lgkmcnt(1)
    ds_read_b64_tr_b16 a[146:147], v5 offset:10760
    v_mfma_f32_16x16x32_bf16 v[92:95], a[112:115], v[12:15], v[92:95]
    ds_read_b128 v[8:11], v0 offset:21760
    ds_read_b64_tr_b16 a[150:151], v5 offset:10816
    v_mfma_f32_16x16x32_bf16 v[96:99], a[116:119], v[12:15], v[96:99]
    ds_read_b64_tr_b16 a[154:155], v5 offset:10824
    ds_read_b64_tr_b16 a[158:159], v5 offset:10880
    v_mfma_f32_16x16x32_bf16 v[100:103], a[120:123], v[12:15], v[100:103]
    ds_read_b64_tr_b16 a[162:163], v5 offset:10888
    v_mfma_f32_16x16x32_bf16 v[104:107], a[124:127], v[12:15], v[104:107]
    ds_read_b64_tr_b16 a[166:167], v23 offset:10752
    v_mfma_f32_16x16x32_bf16 v[108:111], a[128:131], v[12:15], v[108:111]
    s_add_u32 m0, s36, 10240
    v_mfma_f32_16x16x32_bf16 v[112:115], a[132:135], v[12:15], v[112:115]
    v_mfma_f32_16x16x32_bf16 v[116:119], a[136:139], v[12:15], v[116:119]
    s_waitcnt lgkmcnt(5)
    s_waitcnt lgkmcnt(0)
    v_mfma_f32_16x16x32_bf16 v[228:231], a[140:143], v[8:11], v[228:231]
    ds_read_b128 v[12:15], v0 offset:20992
    v_mfma_f32_16x16x32_bf16 v[232:235], a[144:147], v[8:11], v[232:235]
    buffer_load_dwordx4 v19, s[24:27], s34 offen offset:0 lds
    v_mfma_f32_16x16x32_bf16 v[236:239], a[148:151], v[8:11], v[236:239]
    buffer_load_dwordx4 v20, s[24:27], s34 offen offset:1024 lds
    v_mfma_f32_16x16x32_bf16 v[240:243], a[152:155], v[8:11], v[240:243]
    buffer_load_dwordx4 v21, s[24:27], s34 offen offset:2048 lds
    v_mfma_f32_16x16x32_bf16 v[244:247], a[156:159], v[8:11], v[244:247]
    buffer_load_dwordx4 v22, s[24:27], s34 offen offset:3072 lds
    v_mfma_f32_16x16x32_bf16 v[248:251], a[160:163], v[8:11], v[248:251]
    s_waitcnt vmcnt(10)
    ds_read_b64_tr_b16 a[168:169], v5 offset:0
    v_mfma_f32_16x16x32_bf16 v[252:255], a[164:167], v[8:11], v[252:255]
    s_waitcnt lgkmcnt(1)
    ds_read_b64_tr_b16 a[172:173], v5 offset:8
    v_mfma_f32_16x16x32_bf16 v[36:39], a[140:143], v[12:15], v[36:39]
    ds_read_b128 v[8:11], v0 offset:21248
    v_mfma_f32_16x16x32_bf16 v[40:43], a[144:147], v[12:15], v[40:43]
    ds_read_b64_tr_b16 a[176:177], v5 offset:64
    v_mfma_f32_16x16x32_bf16 v[44:47], a[148:151], v[12:15], v[44:47]
    ds_read_b64_tr_b16 a[180:181], v5 offset:72
    v_mfma_f32_16x16x32_bf16 v[48:51], a[152:155], v[12:15], v[48:51]
    ds_read_b64_tr_b16 a[184:185], v5 offset:128
    v_mfma_f32_16x16x32_bf16 v[52:55], a[156:159], v[12:15], v[52:55]
    ds_read_b64_tr_b16 a[188:189], v5 offset:136
    v_mfma_f32_16x16x32_bf16 v[56:59], a[160:163], v[12:15], v[56:59]
    ds_read_b64_tr_b16 a[192:193], v23 offset:0
    v_mfma_f32_16x16x32_bf16 v[60:63], a[164:167], v[12:15], v[60:63]
    s_waitcnt lgkmcnt(5)
    s_add_u32 m0, s36, 0
    s_add_u32 s34, s34, 28672
    v_mfma_f32_16x16x32_bf16 v[64:67], a[140:143], v[8:11], v[64:67]
    ds_read_b128 v[12:15], v0 offset:21504
    s_cmp_ge_u32 s34, s35
    v_mfma_f32_16x16x32_bf16 v[68:71], a[144:147], v[8:11], v[68:71]
    s_waitcnt lgkmcnt(1)
    s_cselect_b32 s34, s45, s34
    v_mfma_f32_16x16x32_bf16 v[72:75], a[148:151], v[8:11], v[72:75]
    buffer_load_dwordx4 v16, s[24:27], s34 offen offset:0 lds
    v_mfma_f32_16x16x32_bf16 v[76:79], a[152:155], v[8:11], v[76:79]
    buffer_load_dwordx4 v17, s[24:27], s34 offen offset:1024 lds
    v_mfma_f32_16x16x32_bf16 v[80:83], a[156:159], v[8:11], v[80:83]
    buffer_load_dwordx4 v18, s[24:27], s34 offen offset:2048 lds
    v_mfma_f32_16x16x32_bf16 v[84:87], a[160:163], v[8:11], v[84:87]
    s_waitcnt vmcnt(10)
    ds_read_b64_tr_b16 a[170:171], v5 offset:3584
    v_mfma_f32_16x16x32_bf16 v[88:91], a[164:167], v[8:11], v[88:91]
    s_waitcnt lgkmcnt(1)
    ds_read_b64_tr_b16 a[174:175], v5 offset:3592
    v_mfma_f32_16x16x32_bf16 v[92:95], a[140:143], v[12:15], v[92:95]
    ds_read_b128 v[8:11], v0 offset:22784
    ds_read_b64_tr_b16 a[178:179], v5 offset:3648
    v_mfma_f32_16x16x32_bf16 v[96:99], a[144:147], v[12:15], v[96:99]
    ds_read_b64_tr_b16 a[182:183], v5 offset:3656
    ds_read_b64_tr_b16 a[186:187], v5 offset:3712
    v_mfma_f32_16x16x32_bf16 v[100:103], a[148:151], v[12:15], v[100:103]
    ds_read_b64_tr_b16 a[190:191], v5 offset:3720
    v_mfma_f32_16x16x32_bf16 v[104:107], a[152:155], v[12:15], v[104:107]
    ds_read_b64_tr_b16 a[194:195], v23 offset:3584
    v_mfma_f32_16x16x32_bf16 v[108:111], a[156:159], v[12:15], v[108:111]
    s_add_u32 m0, s36, 3072
    v_mfma_f32_16x16x32_bf16 v[112:115], a[160:163], v[12:15], v[112:115]
    v_mfma_f32_16x16x32_bf16 v[116:119], a[164:167], v[12:15], v[116:119]
    s_waitcnt lgkmcnt(5)
    s_waitcnt lgkmcnt(0)
    v_mfma_f32_16x16x32_bf16 v[228:231], a[168:171], v[8:11], v[228:231]
    ds_read_b128 v[12:15], v0 offset:22016
    v_mfma_f32_16x16x32_bf16 v[232:235], a[172:175], v[8:11], v[232:235]
    buffer_load_dwordx4 v19, s[24:27], s34 offen offset:0 lds
    v_mfma_f32_16x16x32_bf16 v[236:239], a[176:179], v[8:11], v[236:239]
    buffer_load_dwordx4 v20, s[24:27], s34 offen offset:1024 lds
    v_mfma_f32_16x16x32_bf16 v[240:243], a[180:183], v[8:11], v[240:243]
    buffer_load_dwordx4 v21, s[24:27], s34 offen offset:2048 lds
    v_mfma_f32_16x16x32_bf16 v[244:247], a[184:187], v[8:11], v[244:247]
    buffer_load_dwordx4 v22, s[24:27], s34 offen offset:3072 lds
    v_mfma_f32_16x16x32_bf16 v[248:251], a[188:191], v[8:11], v[248:251]
    s_waitcnt vmcnt(10)
    ds_read_b64_tr_b16 a[196:197], v5 offset:7168
    v_mfma_f32_16x16x32_bf16 v[252:255], a[192:195], v[8:11], v[252:255]
    s_waitcnt lgkmcnt(1)
    ds_read_b64_tr_b16 a[200:201], v5 offset:7176
    v_mfma_f32_16x16x32_bf16 v[36:39], a[168:171], v[12:15], v[36:39]
    ds_read_b128 v[8:11], v0 offset:22272
    v_mfma_f32_16x16x32_bf16 v[40:43], a[172:175], v[12:15], v[40:43]
    ds_read_b64_tr_b16 a[204:205], v5 offset:7232
    v_mfma_f32_16x16x32_bf16 v[44:47], a[176:179], v[12:15], v[44:47]
    ds_read_b64_tr_b16 a[208:209], v5 offset:7240
    v_mfma_f32_16x16x32_bf16 v[48:51], a[180:183], v[12:15], v[48:51]
    ds_read_b64_tr_b16 a[212:213], v5 offset:7296
    v_mfma_f32_16x16x32_bf16 v[52:55], a[184:187], v[12:15], v[52:55]
    ds_read_b64_tr_b16 a[216:217], v5 offset:7304
    v_mfma_f32_16x16x32_bf16 v[56:59], a[188:191], v[12:15], v[56:59]
    ds_read_b64_tr_b16 a[220:221], v23 offset:7168
    v_mfma_f32_16x16x32_bf16 v[60:63], a[192:195], v[12:15], v[60:63]
    s_waitcnt lgkmcnt(5)
    s_add_u32 m0, s36, 7168
    s_add_u32 s34, s34, 28672
    v_mfma_f32_16x16x32_bf16 v[64:67], a[168:171], v[8:11], v[64:67]
    ds_read_b128 v[12:15], v0 offset:22528
    s_cmp_ge_u32 s34, s35
    v_mfma_f32_16x16x32_bf16 v[68:71], a[172:175], v[8:11], v[68:71]
    s_waitcnt lgkmcnt(1)
    s_cselect_b32 s34, s45, s34
    v_mfma_f32_16x16x32_bf16 v[72:75], a[176:179], v[8:11], v[72:75]
    buffer_load_dwordx4 v16, s[24:27], s34 offen offset:0 lds
    v_mfma_f32_16x16x32_bf16 v[76:79], a[180:183], v[8:11], v[76:79]
    buffer_load_dwordx4 v17, s[24:27], s34 offen offset:1024 lds
    v_mfma_f32_16x16x32_bf16 v[80:83], a[184:187], v[8:11], v[80:83]
    buffer_load_dwordx4 v18, s[24:27], s34 offen offset:2048 lds
    v_mfma_f32_16x16x32_bf16 v[84:87], a[188:191], v[8:11], v[84:87]
    s_waitcnt vmcnt(10)
    ds_read_b64_tr_b16 a[198:199], v5 offset:10752
    v_mfma_f32_16x16x32_bf16 v[88:91], a[192:195], v[8:11], v[88:91]
    s_waitcnt lgkmcnt(1)
    ds_read_b64_tr_b16 a[202:203], v5 offset:10760
    v_mfma_f32_16x16x32_bf16 v[92:95], a[168:171], v[12:15], v[92:95]
    ds_read_b128 v[8:11], v0 offset:23808
    ds_read_b64_tr_b16 a[206:207], v5 offset:10816
    v_mfma_f32_16x16x32_bf16 v[96:99], a[172:175], v[12:15], v[96:99]
    ds_read_b64_tr_b16 a[210:211], v5 offset:10824
    ds_read_b64_tr_b16 a[214:215], v5 offset:10880
    v_mfma_f32_16x16x32_bf16 v[100:103], a[176:179], v[12:15], v[100:103]
    ds_read_b64_tr_b16 a[218:219], v5 offset:10888
    v_mfma_f32_16x16x32_bf16 v[104:107], a[180:183], v[12:15], v[104:107]
    ds_read_b64_tr_b16 a[222:223], v23 offset:10752
    v_mfma_f32_16x16x32_bf16 v[108:111], a[184:187], v[12:15], v[108:111]
    s_add_u32 m0, s36, 10240
    v_mfma_f32_16x16x32_bf16 v[112:115], a[188:191], v[12:15], v[112:115]
    v_mfma_f32_16x16x32_bf16 v[116:119], a[192:195], v[12:15], v[116:119]
    s_waitcnt lgkmcnt(5)
    s_waitcnt lgkmcnt(0)
    v_mfma_f32_16x16x32_bf16 v[228:231], a[196:199], v[8:11], v[228:231]
    ds_read_b128 v[12:15], v0 offset:23040
    v_mfma_f32_16x16x32_bf16 v[232:235], a[200:203], v[8:11], v[232:235]
    buffer_load_dwordx4 v19, s[24:27], s34 offen offset:0 lds
    v_mfma_f32_16x16x32_bf16 v[236:239], a[204:207], v[8:11], v[236:239]
    buffer_load_dwordx4 v20, s[24:27], s34 offen offset:1024 lds
    v_mfma_f32_16x16x32_bf16 v[240:243], a[208:211], v[8:11], v[240:243]
    buffer_load_dwordx4 v21, s[24:27], s34 offen offset:2048 lds
    v_mfma_f32_16x16x32_bf16 v[244:247], a[212:215], v[8:11], v[244:247]
    buffer_load_dwordx4 v22, s[24:27], s34 offen offset:3072 lds
    v_mfma_f32_16x16x32_bf16 v[248:251], a[216:219], v[8:11], v[248:251]
    s_waitcnt vmcnt(10)
    ds_read_b64_tr_b16 a[224:225], v5 offset:0
    v_mfma_f32_16x16x32_bf16 v[252:255], a[220:223], v[8:11], v[252:255]
    s_waitcnt lgkmcnt(1)
    ds_read_b64_tr_b16 a[228:229], v5 offset:8
    v_mfma_f32_16x16x32_bf16 v[36:39], a[196:199], v[12:15], v[36:39]
    ds_read_b128 v[8:11], v0 offset:23296
    v_mfma_f32_16x16x32_bf16 v[40:43], a[200:203], v[12:15], v[40:43]
    ds_read_b64_tr_b16 a[232:233], v5 offset:64
    v_mfma_f32_16x16x32_bf16 v[44:47], a[204:207], v[12:15], v[44:47]
    ds_read_b64_tr_b16 a[236:237], v5 offset:72
    v_mfma_f32_16x16x32_bf16 v[48:51], a[208:211], v[12:15], v[48:51]
    ds_read_b64_tr_b16 a[240:241], v5 offset:128
    v_mfma_f32_16x16x32_bf16 v[52:55], a[212:215], v[12:15], v[52:55]
    ds_read_b64_tr_b16 a[244:245], v5 offset:136
    v_mfma_f32_16x16x32_bf16 v[56:59], a[216:219], v[12:15], v[56:59]
    ds_read_b64_tr_b16 a[248:249], v23 offset:0
    v_mfma_f32_16x16x32_bf16 v[60:63], a[220:223], v[12:15], v[60:63]
    s_waitcnt lgkmcnt(5)
    s_add_u32 m0, s36, 0
    s_add_u32 s34, s34, 28672
    v_mfma_f32_16x16x32_bf16 v[64:67], a[196:199], v[8:11], v[64:67]
    ds_read_b128 v[12:15], v0 offset:23552
    s_cmp_ge_u32 s34, s35
    v_mfma_f32_16x16x32_bf16 v[68:71], a[200:203], v[8:11], v[68:71]
    s_waitcnt lgkmcnt(1)
    s_cselect_b32 s34, s45, s34
    v_mfma_f32_16x16x32_bf16 v[72:75], a[204:207], v[8:11], v[72:75]
    buffer_load_dwordx4 v16, s[24:27], s34 offen offset:0 lds
    v_mfma_f32_16x16x32_bf16 v[76:79], a[208:211], v[8:11], v[76:79]
    buffer_load_dwordx4 v17, s[24:27], s34 offen offset:1024 lds
    v_mfma_f32_16x16x32_bf16 v[80:83], a[212:215], v[8:11], v[80:83]
    buffer_load_dwordx4 v18, s[24:27], s34 offen offset:2048 lds
    v_mfma_f32_16x16x32_bf16 v[84:87], a[216:219], v[8:11], v[84:87]
    s_waitcnt vmcnt(10)
    ds_read_b64_tr_b16 a[226:227], v5 offset:3584
    v_mfma_f32_16x16x32_bf16 v[88:91], a[220:223], v[8:11], v[88:91]
    s_waitcnt lgkmcnt(1)
    ds_read_b64_tr_b16 a[230:231], v5 offset:3592
    v_mfma_f32_16x16x32_bf16 v[92:95], a[196:199], v[12:15], v[92:95]
    ds_read_b128 v[8:11], v0 offset:24832
    ds_read_b64_tr_b16 a[234:235], v5 offset:3648
    v_mfma_f32_16x16x32_bf16 v[96:99], a[200:203], v[12:15], v[96:99]
    ds_read_b64_tr_b16 a[238:239], v5 offset:3656
    ds_read_b64_tr_b16 a[242:243], v5 offset:3712
    v_mfma_f32_16x16x32_bf16 v[100:103], a[204:207], v[12:15], v[100:103]
    ds_read_b64_tr_b16 a[246:247], v5 offset:3720
    v_mfma_f32_16x16x32_bf16 v[104:107], a[208:211], v[12:15], v[104:107]
    ds_read_b64_tr_b16 a[250:251], v23 offset:3584
    v_mfma_f32_16x16x32_bf16 v[108:111], a[212:215], v[12:15], v[108:111]
    s_add_u32 m0, s36, 3072
    v_mfma_f32_16x16x32_bf16 v[112:115], a[216:219], v[12:15], v[112:115]
    v_mfma_f32_16x16x32_bf16 v[116:119], a[220:223], v[12:15], v[116:119]
    s_waitcnt lgkmcnt(5)
    s_waitcnt lgkmcnt(0)
    v_mfma_f32_16x16x32_bf16 v[228:231], a[224:227], v[8:11], v[228:231]
    ds_read_b128 v[12:15], v0 offset:24064
    v_mfma_f32_16x16x32_bf16 v[232:235], a[228:231], v[8:11], v[232:235]
    buffer_load_dwordx4 v19, s[24:27], s34 offen offset:0 lds
    v_mfma_f32_16x16x32_bf16 v[236:239], a[232:235], v[8:11], v[236:239]
    buffer_load_dwordx4 v20, s[24:27], s34 offen offset:1024 lds
    v_mfma_f32_16x16x32_bf16 v[240:243], a[236:239], v[8:11], v[240:243]
    buffer_load_dwordx4 v21, s[24:27], s34 offen offset:2048 lds
    v_mfma_f32_16x16x32_bf16 v[244:247], a[240:243], v[8:11], v[244:247]
    buffer_load_dwordx4 v22, s[24:27], s34 offen offset:3072 lds
    v_mfma_f32_16x16x32_bf16 v[248:251], a[244:247], v[8:11], v[248:251]
    s_waitcnt vmcnt(10)
    ds_read_b64_tr_b16 a[252:253], v5 offset:7168
    v_mfma_f32_16x16x32_bf16 v[252:255], a[248:251], v[8:11], v[252:255]
    s_waitcnt lgkmcnt(1)
    ds_read_b64_tr_b16 v[120:121], v5 offset:7176
    v_mfma_f32_16x16x32_bf16 v[36:39], a[224:227], v[12:15], v[36:39]
    ds_read_b128 v[8:11], v0 offset:24320
    v_mfma_f32_16x16x32_bf16 v[40:43], a[228:231], v[12:15], v[40:43]
    ds_read_b64_tr_b16 v[124:125], v5 offset:7232
    v_mfma_f32_16x16x32_bf16 v[44:47], a[232:235], v[12:15], v[44:47]
    ds_read_b64_tr_b16 v[128:129], v5 offset:7240
    v_mfma_f32_16x16x32_bf16 v[48:51], a[236:239], v[12:15], v[48:51]
    ds_read_b64_tr_b16 v[132:133], v5 offset:7296
    v_mfma_f32_16x16x32_bf16 v[52:55], a[240:243], v[12:15], v[52:55]
    ds_read_b64_tr_b16 v[136:137], v5 offset:7304
    v_mfma_f32_16x16x32_bf16 v[56:59], a[244:247], v[12:15], v[56:59]
    ds_read_b64_tr_b16 v[140:141], v23 offset:7168
    v_mfma_f32_16x16x32_bf16 v[60:63], a[248:251], v[12:15], v[60:63]
    s_waitcnt lgkmcnt(5)
    s_add_u32 m0, s36, 7168
    s_add_u32 s34, s34, 28672
    v_mfma_f32_16x16x32_bf16 v[64:67], a[224:227], v[8:11], v[64:67]
    ds_read_b128 v[12:15], v0 offset:24576
    s_cmp_ge_u32 s34, s35
    v_mfma_f32_16x16x32_bf16 v[68:71], a[228:231], v[8:11], v[68:71]
    s_waitcnt lgkmcnt(1)
    s_cselect_b32 s34, s45, s34
    v_mfma_f32_16x16x32_bf16 v[72:75], a[232:235], v[8:11], v[72:75]
    buffer_load_dwordx4 v16, s[24:27], s34 offen offset:0 lds
    v_mfma_f32_16x16x32_bf16 v[76:79], a[236:239], v[8:11], v[76:79]
    buffer_load_dwordx4 v17, s[24:27], s34 offen offset:1024 lds
    v_mfma_f32_16x16x32_bf16 v[80:83], a[240:243], v[8:11], v[80:83]
    buffer_load_dwordx4 v18, s[24:27], s34 offen offset:2048 lds
    v_mfma_f32_16x16x32_bf16 v[84:87], a[244:247], v[8:11], v[84:87]
    s_waitcnt vmcnt(10)
    ds_read_b64_tr_b16 a[254:255], v5 offset:10752
    v_mfma_f32_16x16x32_bf16 v[88:91], a[248:251], v[8:11], v[88:91]
    s_waitcnt lgkmcnt(1)
    ds_read_b64_tr_b16 v[122:123], v5 offset:10760
    v_mfma_f32_16x16x32_bf16 v[92:95], a[224:227], v[12:15], v[92:95]
    ds_read_b128 v[8:11], v0 offset:25856
    ds_read_b64_tr_b16 v[126:127], v5 offset:10816
    v_mfma_f32_16x16x32_bf16 v[96:99], a[228:231], v[12:15], v[96:99]
    ds_read_b64_tr_b16 v[130:131], v5 offset:10824
    ds_read_b64_tr_b16 v[134:135], v5 offset:10880
    v_mfma_f32_16x16x32_bf16 v[100:103], a[232:235], v[12:15], v[100:103]
    ds_read_b64_tr_b16 v[138:139], v5 offset:10888
    v_mfma_f32_16x16x32_bf16 v[104:107], a[236:239], v[12:15], v[104:107]
    ds_read_b64_tr_b16 v[142:143], v23 offset:10752
    v_mfma_f32_16x16x32_bf16 v[108:111], a[240:243], v[12:15], v[108:111]
    s_add_u32 m0, s36, 10240
    v_mfma_f32_16x16x32_bf16 v[112:115], a[244:247], v[12:15], v[112:115]
    v_mfma_f32_16x16x32_bf16 v[116:119], a[248:251], v[12:15], v[116:119]
    s_waitcnt lgkmcnt(5)
    s_waitcnt lgkmcnt(0)
    v_mfma_f32_16x16x32_bf16 v[228:231], a[252:255], v[8:11], v[228:231]
    ds_read_b128 v[12:15], v0 offset:25088
    v_mfma_f32_16x16x32_bf16 v[232:235], v[120:123], v[8:11], v[232:235]
    buffer_load_dwordx4 v19, s[24:27], s34 offen offset:0 lds
    v_mfma_f32_16x16x32_bf16 v[236:239], v[124:127], v[8:11], v[236:239]
    buffer_load_dwordx4 v20, s[24:27], s34 offen offset:1024 lds
    v_mfma_f32_16x16x32_bf16 v[240:243], v[128:131], v[8:11], v[240:243]
    buffer_load_dwordx4 v21, s[24:27], s34 offen offset:2048 lds
    v_mfma_f32_16x16x32_bf16 v[244:247], v[132:135], v[8:11], v[244:247]
    buffer_load_dwordx4 v22, s[24:27], s34 offen offset:3072 lds
    v_mfma_f32_16x16x32_bf16 v[248:251], v[136:139], v[8:11], v[248:251]
    s_waitcnt vmcnt(10)
    ds_read_b64_tr_b16 v[144:145], v5 offset:0
    v_mfma_f32_16x16x32_bf16 v[252:255], v[140:143], v[8:11], v[252:255]
    s_waitcnt lgkmcnt(1)
    ds_read_b64_tr_b16 v[148:149], v5 offset:8
    v_mfma_f32_16x16x32_bf16 v[36:39], a[252:255], v[12:15], v[36:39]
    ds_read_b128 v[8:11], v0 offset:25344
    v_mfma_f32_16x16x32_bf16 v[40:43], v[120:123], v[12:15], v[40:43]
    ds_read_b64_tr_b16 v[152:153], v5 offset:64
    v_mfma_f32_16x16x32_bf16 v[44:47], v[124:127], v[12:15], v[44:47]
    ds_read_b64_tr_b16 v[156:157], v5 offset:72
    v_mfma_f32_16x16x32_bf16 v[48:51], v[128:131], v[12:15], v[48:51]
    ds_read_b64_tr_b16 v[160:161], v5 offset:128
    v_mfma_f32_16x16x32_bf16 v[52:55], v[132:135], v[12:15], v[52:55]
    ds_read_b64_tr_b16 v[164:165], v5 offset:136
    v_mfma_f32_16x16x32_bf16 v[56:59], v[136:139], v[12:15], v[56:59]
    ds_read_b64_tr_b16 v[168:169], v23 offset:0
    v_mfma_f32_16x16x32_bf16 v[60:63], v[140:143], v[12:15], v[60:63]
    s_waitcnt lgkmcnt(5)
    s_add_u32 m0, s36, 0
    s_add_u32 s34, s34, 28672
    v_mfma_f32_16x16x32_bf16 v[64:67], a[252:255], v[8:11], v[64:67]
    ds_read_b128 v[12:15], v0 offset:25600
    s_cmp_ge_u32 s34, s35
    v_mfma_f32_16x16x32_bf16 v[68:71], v[120:123], v[8:11], v[68:71]
    s_waitcnt lgkmcnt(1)
    s_cselect_b32 s34, s45, s34
    v_mfma_f32_16x16x32_bf16 v[72:75], v[124:127], v[8:11], v[72:75]
    buffer_load_dwordx4 v16, s[24:27], s34 offen offset:0 lds
    v_mfma_f32_16x16x32_bf16 v[76:79], v[128:131], v[8:11], v[76:79]
    buffer_load_dwordx4 v17, s[24:27], s34 offen offset:1024 lds
    v_mfma_f32_16x16x32_bf16 v[80:83], v[132:135], v[8:11], v[80:83]
    buffer_load_dwordx4 v18, s[24:27], s34 offen offset:2048 lds
    v_mfma_f32_16x16x32_bf16 v[84:87], v[136:139], v[8:11], v[84:87]
    s_waitcnt vmcnt(10)
    ds_read_b64_tr_b16 v[146:147], v5 offset:3584
    v_mfma_f32_16x16x32_bf16 v[88:91], v[140:143], v[8:11], v[88:91]
    s_waitcnt lgkmcnt(1)
    ds_read_b64_tr_b16 v[150:151], v5 offset:3592
    v_mfma_f32_16x16x32_bf16 v[92:95], a[252:255], v[12:15], v[92:95]
    ds_read_b128 v[8:11], v0 offset:26880
    ds_read_b64_tr_b16 v[154:155], v5 offset:3648
    v_mfma_f32_16x16x32_bf16 v[96:99], v[120:123], v[12:15], v[96:99]
    ds_read_b64_tr_b16 v[158:159], v5 offset:3656
    ds_read_b64_tr_b16 v[162:163], v5 offset:3712
    v_mfma_f32_16x16x32_bf16 v[100:103], v[124:127], v[12:15], v[100:103]
    ds_read_b64_tr_b16 v[166:167], v5 offset:3720
    v_mfma_f32_16x16x32_bf16 v[104:107], v[128:131], v[12:15], v[104:107]
    ds_read_b64_tr_b16 v[170:171], v23 offset:3584
    v_mfma_f32_16x16x32_bf16 v[108:111], v[132:135], v[12:15], v[108:111]
    s_add_u32 m0, s36, 3072
    v_mfma_f32_16x16x32_bf16 v[112:115], v[136:139], v[12:15], v[112:115]
    v_mfma_f32_16x16x32_bf16 v[116:119], v[140:143], v[12:15], v[116:119]
    s_waitcnt lgkmcnt(5)
    s_waitcnt lgkmcnt(0)
    v_mfma_f32_16x16x32_bf16 v[228:231], v[144:147], v[8:11], v[228:231]
    ds_read_b128 v[12:15], v0 offset:26112
    v_mfma_f32_16x16x32_bf16 v[232:235], v[148:151], v[8:11], v[232:235]
    buffer_load_dwordx4 v19, s[24:27], s34 offen offset:0 lds
    v_mfma_f32_16x16x32_bf16 v[236:239], v[152:155], v[8:11], v[236:239]
    buffer_load_dwordx4 v20, s[24:27], s34 offen offset:1024 lds
    v_mfma_f32_16x16x32_bf16 v[240:243], v[156:159], v[8:11], v[240:243]
    buffer_load_dwordx4 v21, s[24:27], s34 offen offset:2048 lds
    v_mfma_f32_16x16x32_bf16 v[244:247], v[160:163], v[8:11], v[244:247]
    buffer_load_dwordx4 v22, s[24:27], s34 offen offset:3072 lds
    v_mfma_f32_16x16x32_bf16 v[248:251], v[164:167], v[8:11], v[248:251]
    s_waitcnt vmcnt(10)
    ds_read_b64_tr_b16 v[172:173], v5 offset:7168
    v_mfma_f32_16x16x32_bf16 v[252:255], v[168:171], v[8:11], v[252:255]
    s_waitcnt lgkmcnt(1)
    ds_read_b64_tr_b16 v[176:177], v5 offset:7176
    v_mfma_f32_16x16x32_bf16 v[36:39], v[144:147], v[12:15], v[36:39]
    ds_read_b128 v[8:11], v0 offset:26368
    v_mfma_f32_16x16x32_bf16 v[40:43], v[148:151], v[12:15], v[40:43]
    ds_read_b64_tr_b16 v[180:181], v5 offset:7232
    v_mfma_f32_16x16x32_bf16 v[44:47], v[152:155], v[12:15], v[44:47]
    ds_read_b64_tr_b16 v[184:185], v5 offset:7240
    v_mfma_f32_16x16x32_bf16 v[48:51], v[156:159], v[12:15], v[48:51]
    ds_read_b64_tr_b16 v[188:189], v5 offset:7296
    v_mfma_f32_16x16x32_bf16 v[52:55], v[160:163], v[12:15], v[52:55]
    ds_read_b64_tr_b16 v[192:193], v5 offset:7304
    v_mfma_f32_16x16x32_bf16 v[56:59], v[164:167], v[12:15], v[56:59]
    ds_read_b64_tr_b16 v[196:197], v23 offset:7168
    v_mfma_f32_16x16x32_bf16 v[60:63], v[168:171], v[12:15], v[60:63]
    s_waitcnt lgkmcnt(5)
    s_add_u32 m0, s36, 7168
    s_add_u32 s34, s34, 28672
    v_mfma_f32_16x16x32_bf16 v[64:67], v[144:147], v[8:11], v[64:67]
    ds_read_b128 v[12:15], v0 offset:26624
    s_cmp_ge_u32 s34, s35
    v_mfma_f32_16x16x32_bf16 v[68:71], v[148:151], v[8:11], v[68:71]
    s_waitcnt lgkmcnt(1)
    s_cselect_b32 s34, s45, s34
    v_mfma_f32_16x16x32_bf16 v[72:75], v[152:155], v[8:11], v[72:75]
    buffer_load_dwordx4 v16, s[24:27], s34 offen offset:0 lds
    v_mfma_f32_16x16x32_bf16 v[76:79], v[156:159], v[8:11], v[76:79]
    buffer_load_dwordx4 v17, s[24:27], s34 offen offset:1024 lds
    v_mfma_f32_16x16x32_bf16 v[80:83], v[160:163], v[8:11], v[80:83]
    buffer_load_dwordx4 v18, s[24:27], s34 offen offset:2048 lds
    v_mfma_f32_16x16x32_bf16 v[84:87], v[164:167], v[8:11], v[84:87]
    s_waitcnt vmcnt(10)
    ds_read_b64_tr_b16 v[174:175], v5 offset:10752
    v_mfma_f32_16x16x32_bf16 v[88:91], v[168:171], v[8:11], v[88:91]
    s_waitcnt lgkmcnt(1)
    ds_read_b64_tr_b16 v[178:179], v5 offset:10760
    v_mfma_f32_16x16x32_bf16 v[92:95], v[144:147], v[12:15], v[92:95]
    ds_read_b128 v[8:11], v0 offset:27904
    ds_read_b64_tr_b16 v[182:183], v5 offset:10816
    v_mfma_f32_16x16x32_bf16 v[96:99], v[148:151], v[12:15], v[96:99]
    ds_read_b64_tr_b16 v[186:187], v5 offset:10824
    ds_read_b64_tr_b16 v[190:191], v5 offset:10880
    v_mfma_f32_16x16x32_bf16 v[100:103], v[152:155], v[12:15], v[100:103]
    ds_read_b64_tr_b16 v[194:195], v5 offset:10888
    v_mfma_f32_16x16x32_bf16 v[104:107], v[156:159], v[12:15], v[104:107]
    ds_read_b64_tr_b16 v[198:199], v23 offset:10752
    v_mfma_f32_16x16x32_bf16 v[108:111], v[160:163], v[12:15], v[108:111]
    s_add_u32 m0, s36, 10240
    v_mfma_f32_16x16x32_bf16 v[112:115], v[164:167], v[12:15], v[112:115]
    v_mfma_f32_16x16x32_bf16 v[116:119], v[168:171], v[12:15], v[116:119]
    s_waitcnt lgkmcnt(5)
    s_waitcnt lgkmcnt(0)
    v_mfma_f32_16x16x32_bf16 v[228:231], v[172:175], v[8:11], v[228:231]
    ds_read_b128 v[12:15], v0 offset:27136
    v_mfma_f32_16x16x32_bf16 v[232:235], v[176:179], v[8:11], v[232:235]
    buffer_load_dwordx4 v19, s[24:27], s34 offen offset:0 lds
    v_mfma_f32_16x16x32_bf16 v[236:239], v[180:183], v[8:11], v[236:239]
    buffer_load_dwordx4 v20, s[24:27], s34 offen offset:1024 lds
    v_mfma_f32_16x16x32_bf16 v[240:243], v[184:187], v[8:11], v[240:243]
    buffer_load_dwordx4 v21, s[24:27], s34 offen offset:2048 lds
    v_mfma_f32_16x16x32_bf16 v[244:247], v[188:191], v[8:11], v[244:247]
    buffer_load_dwordx4 v22, s[24:27], s34 offen offset:3072 lds
    v_mfma_f32_16x16x32_bf16 v[248:251], v[192:195], v[8:11], v[248:251]
    s_waitcnt vmcnt(10)
    ds_read_b64_tr_b16 v[200:201], v5 offset:0
    v_mfma_f32_16x16x32_bf16 v[252:255], v[196:199], v[8:11], v[252:255]
    s_waitcnt lgkmcnt(1)
    ds_read_b64_tr_b16 v[204:205], v5 offset:8
    v_mfma_f32_16x16x32_bf16 v[36:39], v[172:175], v[12:15], v[36:39]
    ds_read_b128 v[8:11], v0 offset:27392
    v_mfma_f32_16x16x32_bf16 v[40:43], v[176:179], v[12:15], v[40:43]
    ds_read_b64_tr_b16 v[208:209], v5 offset:64
    v_mfma_f32_16x16x32_bf16 v[44:47], v[180:183], v[12:15], v[44:47]
    ds_read_b64_tr_b16 v[212:213], v5 offset:72
    v_mfma_f32_16x16x32_bf16 v[48:51], v[184:187], v[12:15], v[48:51]
    ds_read_b64_tr_b16 v[216:217], v5 offset:128
    v_mfma_f32_16x16x32_bf16 v[52:55], v[188:191], v[12:15], v[52:55]
    ds_read_b64_tr_b16 v[220:221], v5 offset:136
    v_mfma_f32_16x16x32_bf16 v[56:59], v[192:195], v[12:15], v[56:59]
    ds_read_b64_tr_b16 v[224:225], v23 offset:0
    v_mfma_f32_16x16x32_bf16 v[60:63], v[196:199], v[12:15], v[60:63]
    s_waitcnt lgkmcnt(5)
    s_add_u32 m0, s36, 0
    s_add_u32 s34, s34, 28672
    v_mfma_f32_16x16x32_bf16 v[64:67], v[172:175], v[8:11], v[64:67]
    ds_read_b128 v[12:15], v0 offset:27648
    s_cmp_ge_u32 s34, s35
    v_mfma_f32_16x16x32_bf16 v[68:71], v[176:179], v[8:11], v[68:71]
    s_waitcnt lgkmcnt(1)
    s_cselect_b32 s34, s45, s34
    v_mfma_f32_16x16x32_bf16 v[72:75], v[180:183], v[8:11], v[72:75]
    buffer_load_dwordx4 v16, s[24:27], s34 offen offset:0 lds
    v_mfma_f32_16x16x32_bf16 v[76:79], v[184:187], v[8:11], v[76:79]
    buffer_load_dwordx4 v17, s[24:27], s34 offen offset:1024 lds
    v_mfma_f32_16x16x32_bf16 v[80:83], v[188:191], v[8:11], v[80:83]
    buffer_load_dwordx4 v18, s[24:27], s34 offen offset:2048 lds
    v_mfma_f32_16x16x32_bf16 v[84:87], v[192:195], v[8:11], v[84:87]
    s_waitcnt vmcnt(10)
    ds_read_b64_tr_b16 v[202:203], v5 offset:3584
    v_mfma_f32_16x16x32_bf16 v[88:91], v[196:199], v[8:11], v[88:91]
    s_waitcnt lgkmcnt(1)
    ds_read_b64_tr_b16 v[206:207], v5 offset:3592
    v_mfma_f32_16x16x32_bf16 v[92:95], v[172:175], v[12:15], v[92:95]
    ds_read_b128 v[8:11], v0 offset:28928
    ds_read_b64_tr_b16 v[210:211], v5 offset:3648
    v_mfma_f32_16x16x32_bf16 v[96:99], v[176:179], v[12:15], v[96:99]
    ds_read_b64_tr_b16 v[214:215], v5 offset:3656
    ds_read_b64_tr_b16 v[218:219], v5 offset:3712
    v_mfma_f32_16x16x32_bf16 v[100:103], v[180:183], v[12:15], v[100:103]
    ds_read_b64_tr_b16 v[222:223], v5 offset:3720
    v_mfma_f32_16x16x32_bf16 v[104:107], v[184:187], v[12:15], v[104:107]
    ds_read_b64_tr_b16 v[226:227], v23 offset:3584
    v_mfma_f32_16x16x32_bf16 v[108:111], v[188:191], v[12:15], v[108:111]
    s_add_u32 m0, s36, 3072
    v_mfma_f32_16x16x32_bf16 v[112:115], v[192:195], v[12:15], v[112:115]
    v_mfma_f32_16x16x32_bf16 v[116:119], v[196:199], v[12:15], v[116:119]
    s_waitcnt lgkmcnt(5)
    s_waitcnt lgkmcnt(0)
    v_mfma_f32_16x16x32_bf16 v[228:231], v[200:203], v[8:11], v[228:231]
    ds_read_b128 v[12:15], v0 offset:28160
    v_mfma_f32_16x16x32_bf16 v[232:235], v[204:207], v[8:11], v[232:235]
    buffer_load_dwordx4 v19, s[24:27], s34 offen offset:0 lds
    v_mfma_f32_16x16x32_bf16 v[236:239], v[208:211], v[8:11], v[236:239]
    buffer_load_dwordx4 v20, s[24:27], s34 offen offset:1024 lds
    v_mfma_f32_16x16x32_bf16 v[240:243], v[212:215], v[8:11], v[240:243]
    buffer_load_dwordx4 v21, s[24:27], s34 offen offset:2048 lds
    v_mfma_f32_16x16x32_bf16 v[244:247], v[216:219], v[8:11], v[244:247]
    buffer_load_dwordx4 v22, s[24:27], s34 offen offset:3072 lds
    v_mfma_f32_16x16x32_bf16 v[248:251], v[220:223], v[8:11], v[248:251]
    s_waitcnt vmcnt(10)
    ds_read_b64_tr_b16 a[0:1], v5 offset:7168
    v_mfma_f32_16x16x32_bf16 v[252:255], v[224:227], v[8:11], v[252:255]
    s_waitcnt lgkmcnt(1)
    ds_read_b64_tr_b16 a[4:5], v5 offset:7176
    v_mfma_f32_16x16x32_bf16 v[36:39], v[200:203], v[12:15], v[36:39]
    ds_read_b128 v[8:11], v0 offset:28416
    v_mbcnt_lo_u32_b32 v17, -1, 0
    v_mfma_f32_16x16x32_bf16 v[40:43], v[204:207], v[12:15], v[40:43]
    ds_read_b64_tr_b16 a[8:9], v5 offset:7232
    v_mbcnt_hi_u32_b32 v17, -1, v17
    v_mfma_f32_16x16x32_bf16 v[44:47], v[208:211], v[12:15], v[44:47]
    ds_read_b64_tr_b16 a[12:13], v5 offset:7240
    v_and_b32 v16, 15, v17
    v_mfma_f32_16x16x32_bf16 v[48:51], v[212:215], v[12:15], v[48:51]
L_pad2:
    s_cbranch_vccnz L_padret0
    ds_read_b64_tr_b16 a[16:17], v5 offset:7296
    v_lshrrev_b32 v17, 4, v17
    v_mfma_f32_16x16x32_bf16 v[52:55], v[216:219], v[12:15], v[52:55]
    ds_read_b64_tr_b16 a[20:21], v5 offset:7304
    v_lshrrev_b32 v18, 2, v16
    v_mfma_f32_16x16x32_bf16 v[56:59], v[220:223], v[12:15], v[56:59]
    ds_read_b64_tr_b16 a[24:25], v23 offset:7168
    v_and_b32 v19, 3, v16
    v_mfma_f32_16x16x32_bf16 v[60:63], v[224:227], v[12:15], v[60:63]
    s_waitcnt lgkmcnt(5)
    v_lshl_add_u32 v18, v18, 5, v19
    v_mul_u32_u24 v18, 896, v18
    v_mfma_f32_16x16x32_bf16 v[64:67], v[200:203], v[8:11], v[64:67]
    ds_read_b128 v[12:15], v0 offset:28672
    v_lshl_add_u32 v18, v17, 4, v18
    v_mfma_f32_16x16x32_bf16 v[68:71], v[204:207], v[8:11], v[68:71]
    s_waitcnt lgkmcnt(1)
    s_lshl_b32 s41, s15, 5
    s_add_u32 s12, s41, s45
    v_mfma_f32_16x16x32_bf16 v[72:75], v[208:211], v[8:11], v[72:75]
    s_waitcnt vmcnt(7)
    ds_read_b64_tr_b16 a[2:3], v5 offset:10752
    v_mfma_f32_16x16x32_bf16 v[76:79], v[212:215], v[8:11], v[76:79]
    ds_read_b64_tr_b16 a[6:7], v5 offset:10760
    v_add_u32 v20, s12, v18
    v_mfma_f32_16x16x32_bf16 v[80:83], v[216:219], v[8:11], v[80:83]
    ds_read_b64_tr_b16 a[10:11], v5 offset:10816
    s_lshr_b32 s13, s32, 1
    v_mfma_f32_16x16x32_bf16 v[84:87], v[220:223], v[8:11], v[84:87]
    ds_read_b64_tr_b16 a[14:15], v5 offset:10824
    s_mul_i32 s12, s13, 448
    v_mfma_f32_16x16x32_bf16 v[88:91], v[224:227], v[8:11], v[88:91]
    s_waitcnt lgkmcnt(4)
    ds_read_b64_tr_b16 a[18:19], v5 offset:10880
    v_mfma_f32_16x16x32_bf16 v[92:95], v[200:203], v[12:15], v[92:95]
    ds_read_b128 v[8:11], v0 offset:29952
    s_mul_i32 s47, s15, 3584
    v_mfma_f32_16x16x32_bf16 v[96:99], v[204:207], v[12:15], v[96:99]
    ds_read_b64_tr_b16 a[22:23], v5 offset:10888
    s_add_u32 s12, s12, 192
    v_mfma_f32_16x16x32_bf16 v[100:103], v[208:211], v[12:15], v[100:103]
    ds_read_b64_tr_b16 a[26:27], v23 offset:10752
    v_add_u32 v21, s12, v18
    v_mfma_f32_16x16x32_bf16 v[104:107], v[212:215], v[12:15], v[104:107]
    v_lshlrev_b32 v18, 5, v16
    v_lshl_add_u32 v19, v17, 3, v18
    v_mfma_f32_16x16x32_bf16 v[108:111], v[216:219], v[12:15], v[108:111]
    v_add_u32 v22, s36, v19
    v_and_b32 v19, 1, v17
    v_mfma_f32_16x16x32_bf16 v[112:115], v[220:223], v[12:15], v[112:115]
    s_waitcnt lgkmcnt(0)
    v_lshl_add_u32 v18, v19, 4, v18
    v_lshrrev_b32 v19, 1, v17
    v_mfma_f32_16x16x32_bf16 v[116:119], v[224:227], v[12:15], v[116:119]
    s_waitcnt lgkmcnt(2)
    v_mul_u32_u24 v19, 40960, v19
    v_add_u32 v18, v18, v19
    v_mfma_f32_16x16x32_bf16 v[228:231], a[0:3], v[8:11], v[228:231]
    ds_read_b128 v[12:15], v0 offset:29184
    s_mul_i32 s12, s13, 81920
    v_mfma_f32_16x16x32_bf16 v[232:235], a[4:7], v[8:11], v[232:235]
    s_lshl_b32 s42, s15, 9
    s_add_u32 s12, s12, s42
    v_add_u32 v16, s12, v18
    v_mfma_f32_16x16x32_bf16 v[236:239], a[8:11], v[8:11], v[236:239]
    v_mfma_f32_16x16x32_bf16 v[240:243], a[12:15], v[8:11], v[240:243]
    s_nop 0
    v_mfma_f32_16x16x32_bf16 v[244:247], a[16:19], v[8:11], v[244:247]
    s_nop 0
    v_mfma_f32_16x16x32_bf16 v[248:251], a[20:23], v[8:11], v[248:251]
    s_nop 0
    v_mfma_f32_16x16x32_bf16 v[252:255], a[24:27], v[8:11], v[252:255]
    s_waitcnt lgkmcnt(0)
    v_mfma_f32_16x16x32_bf16 v[36:39], a[0:3], v[12:15], v[36:39]
    ds_read_b128 v[8:11], v0 offset:29440
    v_mfma_f32_16x16x32_bf16 v[40:43], a[4:7], v[12:15], v[40:43]
    v_cvt_pk_bf16_f32 v235, v234, v235
    v_cvt_pk_bf16_f32 v234, v232, v233
    v_mfma_f32_16x16x32_bf16 v[44:47], a[8:11], v[12:15], v[44:47]
    v_cvt_pk_bf16_f32 v232, v228, v229
    v_cvt_pk_bf16_f32 v233, v230, v231
    v_mfma_f32_16x16x32_bf16 v[48:51], a[12:15], v[12:15], v[48:51]
    v_cvt_pk_bf16_f32 v243, v242, v243
    v_cvt_pk_bf16_f32 v242, v240, v241
    v_mfma_f32_16x16x32_bf16 v[52:55], a[16:19], v[12:15], v[52:55]
    v_cvt_pk_bf16_f32 v240, v236, v237
    v_cvt_pk_bf16_f32 v241, v238, v239
    v_mfma_f32_16x16x32_bf16 v[56:59], a[20:23], v[12:15], v[56:59]
    v_cvt_pk_bf16_f32 v251, v250, v251
    v_cvt_pk_bf16_f32 v250, v248, v249
    v_mfma_f32_16x16x32_bf16 v[60:63], a[24:27], v[12:15], v[60:63]
    s_waitcnt lgkmcnt(0)
    v_cvt_pk_bf16_f32 v248, v244, v245
    v_cvt_pk_bf16_f32 v249, v246, v247
    v_mfma_f32_16x16x32_bf16 v[64:67], a[0:3], v[8:11], v[64:67]
    ds_read_b128 v[12:15], v0 offset:29696
    v_mfma_f32_16x16x32_bf16 v[68:71], a[4:7], v[8:11], v[68:71]
    v_cvt_pk_bf16_f32 v43, v42, v43
    v_cvt_pk_bf16_f32 v42, v40, v41
    v_mfma_f32_16x16x32_bf16 v[72:75], a[8:11], v[8:11], v[72:75]
    v_cvt_pk_bf16_f32 v40, v36, v37
    v_cvt_pk_bf16_f32 v41, v38, v39
    v_mfma_f32_16x16x32_bf16 v[76:79], a[12:15], v[8:11], v[76:79]
    v_cvt_pk_bf16_f32 v51, v50, v51
    v_cvt_pk_bf16_f32 v50, v48, v49
    v_mfma_f32_16x16x32_bf16 v[80:83], a[16:19], v[8:11], v[80:83]
    v_cvt_pk_bf16_f32 v48, v44, v45
    v_cvt_pk_bf16_f32 v49, v46, v47
    v_mfma_f32_16x16x32_bf16 v[84:87], a[20:23], v[8:11], v[84:87]
    v_cvt_pk_bf16_f32 v59, v58, v59
    v_cvt_pk_bf16_f32 v58, v56, v57
    v_mfma_f32_16x16x32_bf16 v[88:91], a[24:27], v[8:11], v[88:91]
    s_waitcnt lgkmcnt(0)
    v_cvt_pk_bf16_f32 v56, v52, v53
    v_cvt_pk_bf16_f32 v57, v54, v55
    v_mfma_f32_16x16x32_bf16 v[92:95], a[0:3], v[12:15], v[92:95]
    ds_read_b128 v[8:11], v0 offset:30464
    s_add_u32 s46, s38, 10752
    v_mfma_f32_16x16x32_bf16 v[96:99], a[4:7], v[12:15], v[96:99]
    buffer_store_dwordx4 v[232:235], v20, s[28:31], s46 offen offset:0 sc1
    v_mfma_f32_16x16x32_bf16 v[100:103], a[8:11], v[12:15], v[100:103]
    s_nop 1
    v_mfma_f32_16x16x32_bf16 v[104:107], a[12:15], v[12:15], v[104:107]
    s_nop 1
    v_mfma_f32_16x16x32_bf16 v[108:111], a[16:19], v[12:15], v[108:111]
    v_cvt_pk_bf16_f32 v36, v92, v93
    v_cvt_pk_bf16_f32 v37, v94, v95
    v_mfma_f32_16x16x32_bf16 v[112:115], a[20:23], v[12:15], v[112:115]
    v_cvt_pk_bf16_f32 v38, v96, v97
    v_cvt_pk_bf16_f32 v39, v98, v99
    v_mfma_f32_16x16x32_bf16 v[116:119], a[24:27], v[12:15], v[116:119]
    s_waitcnt lgkmcnt(0)
    v_cvt_pk_bf16_f32 v44, v100, v101
    v_cvt_pk_bf16_f32 v45, v102, v103
    v_mfma_f32_16x16x32_bf16 v[92:95], a[28:31], v[8:11], 0
    ds_read_b128 v[12:15], v0 offset:30720
    v_mfma_f32_16x16x32_bf16 v[96:99], a[32:35], v[8:11], 0
    v_cvt_pk_bf16_f32 v46, v104, v105
    v_cvt_pk_bf16_f32 v47, v106, v107
    v_mfma_f32_16x16x32_bf16 v[100:103], a[36:39], v[8:11], 0
    v_cvt_pk_bf16_f32 v52, v108, v109
    v_cvt_pk_bf16_f32 v53, v110, v111
    v_mfma_f32_16x16x32_bf16 v[104:107], a[40:43], v[8:11], 0
    v_cvt_pk_bf16_f32 v54, v112, v113
    v_cvt_pk_bf16_f32 v55, v114, v115
    v_mfma_f32_16x16x32_bf16 v[108:111], a[44:47], v[8:11], 0
    v_cvt_pk_bf16_f32 v18, v116, v117
    v_cvt_pk_bf16_f32 v19, v118, v119
    v_mfma_f32_16x16x32_bf16 v[112:115], a[48:51], v[8:11], 0
    v_mfma_f32_16x16x32_bf16 v[116:119], a[52:55], v[8:11], 0
    s_waitcnt lgkmcnt(0)
    v_mfma_f32_16x16x32_bf16 v[92:95], a[56:59], v[12:15], v[92:95]
    ds_read_b128 v[8:11], v0 offset:30976
    v_mfma_f32_16x16x32_bf16 v[96:99], a[60:63], v[12:15], v[96:99]
    ds_write_b64 v22, v[18:19] offset:11776
    v_mfma_f32_16x16x32_bf16 v[100:103], a[64:67], v[12:15], v[100:103]
    v_cvt_pk_bf16_f32 v252, v252, v253
    v_cvt_pk_bf16_f32 v253, v254, v255
    v_mfma_f32_16x16x32_bf16 v[104:107], a[68:71], v[12:15], v[104:107]
    ds_write_b64 v22, v[252:253] offset:12288
    v_mfma_f32_16x16x32_bf16 v[108:111], a[72:75], v[12:15], v[108:111]
    v_cvt_pk_bf16_f32 v60, v60, v61
    v_cvt_pk_bf16_f32 v61, v62, v63
    v_mfma_f32_16x16x32_bf16 v[112:115], a[76:79], v[12:15], v[112:115]
    ds_write_b64 v22, v[60:61] offset:10752
    v_mfma_f32_16x16x32_bf16 v[116:119], a[80:83], v[12:15], v[116:119]
    s_waitcnt lgkmcnt(3)
    v_cvt_pk_bf16_f32 v88, v88, v89
    v_cvt_pk_bf16_f32 v89, v90, v91
    v_mfma_f32_16x16x32_bf16 v[92:95], a[84:87], v[8:11], v[92:95]
    ds_read_b128 v[12:15], v0 offset:31232
    v_mfma_f32_16x16x32_bf16 v[96:99], a[88:91], v[8:11], v[96:99]
    ds_write_b64 v22, v[88:89] offset:11264
    v_mfma_f32_16x16x32_bf16 v[100:103], a[92:95], v[8:11], v[100:103]
    v_cvt_pk_bf16_f32 v71, v70, v71
    v_cvt_pk_bf16_f32 v70, v68, v69
    v_mfma_f32_16x16x32_bf16 v[104:107], a[96:99], v[8:11], v[104:107]
    v_cvt_pk_bf16_f32 v68, v64, v65
    v_cvt_pk_bf16_f32 v69, v66, v67
    v_mfma_f32_16x16x32_bf16 v[108:111], a[100:103], v[8:11], v[108:111]
    v_cvt_pk_bf16_f32 v79, v78, v79
    v_cvt_pk_bf16_f32 v78, v76, v77
    v_mfma_f32_16x16x32_bf16 v[112:115], a[104:107], v[8:11], v[112:115]
    v_cvt_pk_bf16_f32 v76, v72, v73
    v_cvt_pk_bf16_f32 v77, v74, v75
    v_mfma_f32_16x16x32_bf16 v[116:119], a[108:111], v[8:11], v[116:119]
    s_waitcnt lgkmcnt(1)
    v_cvt_pk_bf16_f32 v87, v86, v87
    v_cvt_pk_bf16_f32 v86, v84, v85
    v_mfma_f32_16x16x32_bf16 v[92:95], a[112:115], v[12:15], v[92:95]
    ds_read_b128 v[8:11], v0 offset:31488
    v_cvt_pk_bf16_f32 v84, v80, v81
    v_mfma_f32_16x16x32_bf16 v[96:99], a[116:119], v[12:15], v[96:99]
    s_add_u32 s46, s38, 10752
    v_cvt_pk_bf16_f32 v85, v82, v83
    v_mfma_f32_16x16x32_bf16 v[100:103], a[120:123], v[12:15], v[100:103]
    buffer_store_dwordx4 v[240:243], v20, s[28:31], s46 offen offset:64 sc1
    v_mfma_f32_16x16x32_bf16 v[104:107], a[124:127], v[12:15], v[104:107]
    s_add_u32 s46, s38, 10752
    v_mfma_f32_16x16x32_bf16 v[108:111], a[128:131], v[12:15], v[108:111]
    buffer_store_dwordx4 v[248:251], v20, s[28:31], s46 offen offset:128 sc1
    v_mfma_f32_16x16x32_bf16 v[112:115], a[132:135], v[12:15], v[112:115]
    v_mfma_f32_16x16x32_bf16 v[116:119], a[136:139], v[12:15], v[116:119]
    s_waitcnt lgkmcnt(0)
    v_mfma_f32_16x16x32_bf16 v[92:95], a[140:143], v[8:11], v[92:95]
    ds_read_b128 v[12:15], v0 offset:31744
    v_mfma_f32_16x16x32_bf16 v[96:99], a[144:147], v[8:11], v[96:99]
    v_mfma_f32_16x16x32_bf16 v[100:103], a[148:151], v[8:11], v[100:103]
    v_mfma_f32_16x16x32_bf16 v[104:107], a[152:155], v[8:11], v[104:107]
    v_mfma_f32_16x16x32_bf16 v[108:111], a[156:159], v[8:11], v[108:111]
    s_add_u32 s46, s38, 0
    v_mfma_f32_16x16x32_bf16 v[112:115], a[160:163], v[8:11], v[112:115]
    buffer_store_dwordx4 v[40:43], v20, s[28:31], s46 offen offset:0 sc1
    v_mfma_f32_16x16x32_bf16 v[116:119], a[164:167], v[8:11], v[116:119]
    s_waitcnt lgkmcnt(0)
    v_mfma_f32_16x16x32_bf16 v[92:95], a[168:171], v[12:15], v[92:95]
    ds_read_b128 v[8:11], v0 offset:32000
    v_mfma_f32_16x16x32_bf16 v[96:99], a[172:175], v[12:15], v[96:99]
    v_mfma_f32_16x16x32_bf16 v[100:103], a[176:179], v[12:15], v[100:103]
    v_mfma_f32_16x16x32_bf16 v[104:107], a[180:183], v[12:15], v[104:107]
    v_mfma_f32_16x16x32_bf16 v[108:111], a[184:187], v[12:15], v[108:111]
    v_mfma_f32_16x16x32_bf16 v[112:115], a[188:191], v[12:15], v[112:115]
    v_mfma_f32_16x16x32_bf16 v[116:119], a[192:195], v[12:15], v[116:119]
    s_waitcnt lgkmcnt(0)
    v_mfma_f32_16x16x32_bf16 v[92:95], a[196:199], v[8:11], v[92:95]
    ds_read_b128 v[12:15], v0 offset:32256
    v_mfma_f32_16x16x32_bf16 v[96:99], a[200:203], v[8:11], v[96:99]
    v_mfma_f32_16x16x32_bf16 v[100:103], a[204:207], v[8:11], v[100:103]
    v_mfma_f32_16x16x32_bf16 v[104:107], a[208:211], v[8:11], v[104:107]
    s_waitcnt vmcnt(4)
    ds_read_b64_tr_b16 v[228:229], v5 offset:0
    v_mfma_f32_16x16x32_bf16 v[108:111], a[212:215], v[8:11], v[108:111]
    s_add_u32 s46, s38, 3584
    ds_read_b64_tr_b16 v[232:233], v5 offset:8
    v_mfma_f32_16x16x32_bf16 v[112:115], a[216:219], v[8:11], v[112:115]
    buffer_store_dwordx4 v[68:71], v20, s[28:31], s46 offen offset:0 sc1
    v_mfma_f32_16x16x32_bf16 v[116:119], a[220:223], v[8:11], v[116:119]
    s_waitcnt lgkmcnt(2)
    ds_read_b64_tr_b16 v[236:237], v5 offset:64
    v_mfma_f32_16x16x32_bf16 v[92:95], a[224:227], v[12:15], v[92:95]
    ds_read_b128 v[8:11], v0 offset:32512
    v_mfma_f32_16x16x32_bf16 v[96:99], a[228:231], v[12:15], v[96:99]
    ds_read_b64_tr_b16 v[240:241], v5 offset:72
    v_mfma_f32_16x16x32_bf16 v[100:103], a[232:235], v[12:15], v[100:103]
    ds_read_b64_tr_b16 v[244:245], v5 offset:128
    v_mfma_f32_16x16x32_bf16 v[104:107], a[236:239], v[12:15], v[104:107]
    ds_read_b64_tr_b16 v[248:249], v5 offset:136
    v_mfma_f32_16x16x32_bf16 v[108:111], a[240:243], v[12:15], v[108:111]
    ds_read_b64_tr_b16 v[252:253], v23 offset:0
    v_mfma_f32_16x16x32_bf16 v[112:115], a[244:247], v[12:15], v[112:115]
    ds_read_b64_tr_b16 v[230:231], v5 offset:3584
    v_mfma_f32_16x16x32_bf16 v[116:119], a[248:251], v[12:15], v[116:119]
    s_waitcnt lgkmcnt(5)
    ds_read_b64_tr_b16 v[234:235], v5 offset:3592
    v_mfma_f32_16x16x32_bf16 v[92:95], a[252:255], v[8:11], v[92:95]
    ds_read_b128 v[12:15], v0 offset:32768
    v_mfma_f32_16x16x32_bf16 v[96:99], v[120:123], v[8:11], v[96:99]
    ds_read_b64_tr_b16 v[238:239], v5 offset:3648
    v_mfma_f32_16x16x32_bf16 v[100:103], v[124:127], v[8:11], v[100:103]
    ds_read_b64_tr_b16 v[242:243], v5 offset:3656
    v_mfma_f32_16x16x32_bf16 v[104:107], v[128:131], v[8:11], v[104:107]
    ds_read_b64_tr_b16 v[246:247], v5 offset:3712
    v_mfma_f32_16x16x32_bf16 v[108:111], v[132:135], v[8:11], v[108:111]
    s_add_u32 s46, s38, 3584
    ds_read_b64_tr_b16 v[250:251], v5 offset:3720
    v_mfma_f32_16x16x32_bf16 v[112:115], v[136:139], v[8:11], v[112:115]
    buffer_store_dwordx4 v[76:79], v20, s[28:31], s46 offen offset:64 sc1
    v_mfma_f32_16x16x32_bf16 v[116:119], v[140:143], v[8:11], v[116:119]
    s_waitcnt lgkmcnt(4)
    ds_read_b64_tr_b16 v[254:255], v23 offset:3584
    v_mfma_f32_16x16x32_bf16 v[92:95], v[144:147], v[12:15], v[92:95]
    ds_read_b128 v[8:11], v0 offset:33024
    v_mfma_f32_16x16x32_bf16 v[96:99], v[148:151], v[12:15], v[96:99]
    v_mfma_f32_16x16x32_bf16 v[100:103], v[152:155], v[12:15], v[100:103]
    v_mfma_f32_16x16x32_bf16 v[104:107], v[156:159], v[12:15], v[104:107]
    v_mfma_f32_16x16x32_bf16 v[108:111], v[160:163], v[12:15], v[108:111]
    v_mfma_f32_16x16x32_bf16 v[112:115], v[164:167], v[12:15], v[112:115]
    v_mfma_f32_16x16x32_bf16 v[116:119], v[168:171], v[12:15], v[116:119]
    s_waitcnt lgkmcnt(0)
    v_mfma_f32_16x16x32_bf16 v[92:95], v[172:175], v[8:11], v[92:95]
    ds_read_b128 v[12:15], v0 offset:33280
    v_mfma_f32_16x16x32_bf16 v[96:99], v[176:179], v[8:11], v[96:99]
    v_mfma_f32_16x16x32_bf16 v[100:103], v[180:183], v[8:11], v[100:103]
    v_mfma_f32_16x16x32_bf16 v[104:107], v[184:187], v[8:11], v[104:107]
    v_mfma_f32_16x16x32_bf16 v[108:111], v[188:191], v[8:11], v[108:111]
    s_add_u32 s46, s38, 3584
    v_mfma_f32_16x16x32_bf16 v[112:115], v[192:195], v[8:11], v[112:115]
    buffer_store_dwordx4 v[84:87], v20, s[28:31], s46 offen offset:128 sc1
    v_mfma_f32_16x16x32_bf16 v[116:119], v[196:199], v[8:11], v[116:119]
    s_waitcnt lgkmcnt(0)
    v_mfma_f32_16x16x32_bf16 v[92:95], v[200:203], v[12:15], v[92:95]
    ds_read_b128 v[8:11], v0 offset:33536
    v_mfma_f32_16x16x32_bf16 v[96:99], v[204:207], v[12:15], v[96:99]
    v_mfma_f32_16x16x32_bf16 v[100:103], v[208:211], v[12:15], v[100:103]
    v_mfma_f32_16x16x32_bf16 v[104:107], v[212:215], v[12:15], v[104:107]
    v_mfma_f32_16x16x32_bf16 v[108:111], v[216:219], v[12:15], v[108:111]
    v_mfma_f32_16x16x32_bf16 v[112:115], v[220:223], v[12:15], v[112:115]
    v_mfma_f32_16x16x32_bf16 v[116:119], v[224:227], v[12:15], v[116:119]
    s_waitcnt lgkmcnt(0)
    v_mfma_f32_16x16x32_bf16 v[92:95], a[0:3], v[8:11], v[92:95]
    ds_read_b128 v[12:15], v0 offset:30208
    v_mfma_f32_16x16x32_bf16 v[96:99], a[4:7], v[8:11], v[96:99]
    v_mfma_f32_16x16x32_bf16 v[100:103], a[8:11], v[8:11], v[100:103]
    v_mfma_f32_16x16x32_bf16 v[104:107], a[12:15], v[8:11], v[104:107]
    v_mfma_f32_16x16x32_bf16 v[108:111], a[16:19], v[8:11], v[108:111]
    v_mfma_f32_16x16x32_bf16 v[112:115], a[20:23], v[8:11], v[112:115]
    v_mfma_f32_16x16x32_bf16 v[116:119], a[24:27], v[8:11], v[116:119]
    s_waitcnt lgkmcnt(0)
    v_mfma_f32_16x16x32_bf16 v[92:95], v[228:231], v[12:15], v[92:95]
    s_barrier
    ds_read_b128 v[8:11], v0 offset:34048
    v_mfma_f32_16x16x32_bf16 v[96:99], v[232:235], v[12:15], v[96:99]
    s_nop 0
    v_mfma_f32_16x16x32_bf16 v[100:103], v[236:239], v[12:15], v[100:103]
    s_nop 0
    v_mfma_f32_16x16x32_bf16 v[104:107], v[240:243], v[12:15], v[104:107]
    s_nop 1
    v_mfma_f32_16x16x32_bf16 v[108:111], v[244:247], v[12:15], v[108:111]
    v_cvt_pk_bf16_f32 v64, v92, v93
    v_cvt_pk_bf16_f32 v65, v94, v95
    v_mfma_f32_16x16x32_bf16 v[112:115], v[248:251], v[12:15], v[112:115]
    v_cvt_pk_bf16_f32 v66, v96, v97
    v_cvt_pk_bf16_f32 v67, v98, v99
    v_mfma_f32_16x16x32_bf16 v[116:119], v[252:255], v[12:15], v[116:119]
    s_waitcnt lgkmcnt(0)
    v_cvt_pk_bf16_f32 v72, v100, v101
    v_cvt_pk_bf16_f32 v73, v102, v103
    v_mfma_f32_16x16x32_bf16 v[92:95], a[28:31], v[8:11], 0
    ds_read_b128 v[12:15], v0 offset:34304
    v_mfma_f32_16x16x32_bf16 v[96:99], a[32:35], v[8:11], 0
    v_cvt_pk_bf16_f32 v74, v104, v105
    v_cvt_pk_bf16_f32 v75, v106, v107
    v_mfma_f32_16x16x32_bf16 v[100:103], a[36:39], v[8:11], 0
    v_cvt_pk_bf16_f32 v80, v108, v109
    v_cvt_pk_bf16_f32 v81, v110, v111
    v_mfma_f32_16x16x32_bf16 v[104:107], a[40:43], v[8:11], 0
    v_cvt_pk_bf16_f32 v82, v112, v113
    v_cvt_pk_bf16_f32 v83, v114, v115
    v_mfma_f32_16x16x32_bf16 v[108:111], a[44:47], v[8:11], 0
    v_cvt_pk_bf16_f32 v18, v116, v117
    v_cvt_pk_bf16_f32 v19, v118, v119
    v_mfma_f32_16x16x32_bf16 v[112:115], a[48:51], v[8:11], 0
    v_mfma_f32_16x16x32_bf16 v[116:119], a[52:55], v[8:11], 0
    s_waitcnt lgkmcnt(0)
    v_mfma_f32_16x16x32_bf16 v[92:95], a[56:59], v[12:15], v[92:95]
    ds_read_b128 v[8:11], v0 offset:34560
    v_mfma_f32_16x16x32_bf16 v[96:99], a[60:63], v[12:15], v[96:99]
    ds_write_b64 v22, v[18:19] offset:12800
    v_mfma_f32_16x16x32_bf16 v[100:103], a[64:67], v[12:15], v[100:103]
    s_add_u32 s46, s38, 0
    v_mfma_f32_16x16x32_bf16 v[104:107], a[68:71], v[12:15], v[104:107]
    buffer_store_dwordx4 v[48:51], v20, s[28:31], s46 offen offset:64 sc1
    v_mfma_f32_16x16x32_bf16 v[108:111], a[72:75], v[12:15], v[108:111]
    v_mfma_f32_16x16x32_bf16 v[112:115], a[76:79], v[12:15], v[112:115]
    v_mfma_f32_16x16x32_bf16 v[116:119], a[80:83], v[12:15], v[116:119]
    s_waitcnt lgkmcnt(1)
    v_mfma_f32_16x16x32_bf16 v[92:95], a[84:87], v[8:11], v[92:95]
    ds_read_b128 v[12:15], v0 offset:34816
    v_mfma_f32_16x16x32_bf16 v[96:99], a[88:91], v[8:11], v[96:99]
    v_mfma_f32_16x16x32_bf16 v[100:103], a[92:95], v[8:11], v[100:103]
    v_mfma_f32_16x16x32_bf16 v[104:107], a[96:99], v[8:11], v[104:107]
    ds_write_b128 v1, v[24:27] offset:7168
    v_mfma_f32_16x16x32_bf16 v[108:111], a[100:103], v[8:11], v[108:111]
    v_mfma_f32_16x16x32_bf16 v[112:115], a[104:107], v[8:11], v[112:115]
    v_mfma_f32_16x16x32_bf16 v[116:119], a[108:111], v[8:11], v[116:119]
    s_waitcnt lgkmcnt(1)
    v_mfma_f32_16x16x32_bf16 v[92:95], a[112:115], v[12:15], v[92:95]
    ds_read_b128 v[8:11], v0 offset:35072
    v_mfma_f32_16x16x32_bf16 v[96:99], a[116:119], v[12:15], v[96:99]
    ds_read_b128 v[60:63], v16 offset:10752
    v_mfma_f32_16x16x32_bf16 v[100:103], a[120:123], v[12:15], v[100:103]
    s_add_u32 s46, s38, 0
    v_mfma_f32_16x16x32_bf16 v[104:107], a[124:127], v[12:15], v[104:107]
    buffer_store_dwordx4 v[56:59], v20, s[28:31], s46 offen offset:128 sc1
    v_mfma_f32_16x16x32_bf16 v[108:111], a[128:131], v[12:15], v[108:111]
    v_mfma_f32_16x16x32_bf16 v[112:115], a[132:135], v[12:15], v[112:115]
    v_mfma_f32_16x16x32_bf16 v[116:119], a[136:139], v[12:15], v[116:119]
    s_waitcnt lgkmcnt(1)
    v_mfma_f32_16x16x32_bf16 v[92:95], a[140:143], v[8:11], v[92:95]
    ds_read_b128 v[12:15], v0 offset:35328
    v_mfma_f32_16x16x32_bf16 v[96:99], a[144:147], v[8:11], v[96:99]
    s_add_u32 s46, s47, 0
    s_add_u32 s46, s46, s38
    v_mfma_f32_16x16x32_bf16 v[100:103], a[148:151], v[8:11], v[100:103]
    s_waitcnt lgkmcnt(1)
    v_mfma_f32_16x16x32_bf16 v[104:107], a[152:155], v[8:11], v[104:107]
    buffer_store_dwordx4 v[60:63], v21, s[28:31], s46 offen sc1
    v_mfma_f32_16x16x32_bf16 v[108:111], a[156:159], v[8:11], v[108:111]
    v_mfma_f32_16x16x32_bf16 v[112:115], a[160:163], v[8:11], v[112:115]
    v_mfma_f32_16x16x32_bf16 v[116:119], a[164:167], v[8:11], v[116:119]
    s_waitcnt lgkmcnt(0)
    v_mfma_f32_16x16x32_bf16 v[92:95], a[168:171], v[12:15], v[92:95]
    ds_read_b128 v[8:11], v0 offset:35584
    v_mfma_f32_16x16x32_bf16 v[96:99], a[172:175], v[12:15], v[96:99]
    v_mfma_f32_16x16x32_bf16 v[100:103], a[176:179], v[12:15], v[100:103]
    v_mfma_f32_16x16x32_bf16 v[104:107], a[180:183], v[12:15], v[104:107]
    v_mfma_f32_16x16x32_bf16 v[108:111], a[184:187], v[12:15], v[108:111]
    ds_write_b128 v2, v[28:31] offset:7168
    v_mfma_f32_16x16x32_bf16 v[112:115], a[188:191], v[12:15], v[112:115]
    v_mfma_f32_16x16x32_bf16 v[116:119], a[192:195], v[12:15], v[116:119]
    s_waitcnt lgkmcnt(1)
    v_mfma_f32_16x16x32_bf16 v[92:95], a[196:199], v[8:11], v[92:95]
    ds_read_b128 v[12:15], v0 offset:35840
    v_mfma_f32_16x16x32_bf16 v[96:99], a[200:203], v[8:11], v[96:99]
    v_mfma_f32_16x16x32_bf16 v[100:103], a[204:207], v[8:11], v[100:103]
    v_mfma_f32_16x16x32_bf16 v[104:107], a[208:211], v[8:11], v[104:107]
    s_add_u32 s46, s38, 7168
    v_mfma_f32_16x16x32_bf16 v[108:111], a[212:215], v[8:11], v[108:111]
    buffer_store_dwordx4 v[36:39], v20, s[28:31], s46 offen offset:0 sc1
    v_mfma_f32_16x16x32_bf16 v[112:115], a[216:219], v[8:11], v[112:115]
    v_mfma_f32_16x16x32_bf16 v[116:119], a[220:223], v[8:11], v[116:119]
    s_waitcnt lgkmcnt(0)
    v_mfma_f32_16x16x32_bf16 v[92:95], a[224:227], v[12:15], v[92:95]
    ds_read_b128 v[8:11], v0 offset:36096
    v_mfma_f32_16x16x32_bf16 v[96:99], a[228:231], v[12:15], v[96:99]
    v_mfma_f32_16x16x32_bf16 v[100:103], a[232:235], v[12:15], v[100:103]
    v_mfma_f32_16x16x32_bf16 v[104:107], a[236:239], v[12:15], v[104:107]
    s_add_u32 s46, s38, 7168
    v_mfma_f32_16x16x32_bf16 v[108:111], a[240:243], v[12:15], v[108:111]
    buffer_store_dwordx4 v[44:47], v20, s[28:31], s46 offen offset:64 sc1
    v_mfma_f32_16x16x32_bf16 v[112:115], a[244:247], v[12:15], v[112:115]
    v_mfma_f32_16x16x32_bf16 v[116:119], a[248:251], v[12:15], v[116:119]
    s_waitcnt lgkmcnt(0)
    v_mfma_f32_16x16x32_bf16 v[92:95], a[252:255], v[8:11], v[92:95]
    ds_read_b128 v[12:15], v0 offset:36352
    v_mfma_f32_16x16x32_bf16 v[96:99], v[120:123], v[8:11], v[96:99]
    v_mfma_f32_16x16x32_bf16 v[100:103], v[124:127], v[8:11], v[100:103]
    v_mfma_f32_16x16x32_bf16 v[104:107], v[128:131], v[8:11], v[104:107]
    v_mfma_f32_16x16x32_bf16 v[108:111], v[132:135], v[8:11], v[108:111]
    ds_write_b128 v3, v[32:35] offset:7168
    v_mfma_f32_16x16x32_bf16 v[112:115], v[136:139], v[8:11], v[112:115]
    v_mfma_f32_16x16x32_bf16 v[116:119], v[140:143], v[8:11], v[116:119]
    s_waitcnt lgkmcnt(1)
    v_mfma_f32_16x16x32_bf16 v[92:95], v[144:147], v[12:15], v[92:95]
    ds_read_b128 v[8:11], v0 offset:36608
    v_mfma_f32_16x16x32_bf16 v[96:99], v[148:151], v[12:15], v[96:99]
    v_mfma_f32_16x16x32_bf16 v[100:103], v[152:155], v[12:15], v[100:103]
    v_mfma_f32_16x16x32_bf16 v[104:107], v[156:159], v[12:15], v[104:107]
    v_mfma_f32_16x16x32_bf16 v[108:111], v[160:163], v[12:15], v[108:111]
    s_add_u32 s46, s38, 7168
    v_mfma_f32_16x16x32_bf16 v[112:115], v[164:167], v[12:15], v[112:115]
    buffer_store_dwordx4 v[52:55], v20, s[28:31], s46 offen offset:128 sc1
    v_mfma_f32_16x16x32_bf16 v[116:119], v[168:171], v[12:15], v[116:119]
    s_waitcnt lgkmcnt(0)
    v_mfma_f32_16x16x32_bf16 v[92:95], v[172:175], v[8:11], v[92:95]
    ds_read_b128 v[12:15], v0 offset:36864
    v_mfma_f32_16x16x32_bf16 v[96:99], v[176:179], v[8:11], v[96:99]
    v_mfma_f32_16x16x32_bf16 v[100:103], v[180:183], v[8:11], v[100:103]
    v_mfma_f32_16x16x32_bf16 v[104:107], v[184:187], v[8:11], v[104:107]
    v_mfma_f32_16x16x32_bf16 v[108:111], v[188:191], v[8:11], v[108:111]
    v_mfma_f32_16x16x32_bf16 v[112:115], v[192:195], v[8:11], v[112:115]
    ds_write_b64 v4, v[6:7] offset:7168
    v_mfma_f32_16x16x32_bf16 v[116:119], v[196:199], v[8:11], v[116:119]
    s_waitcnt lgkmcnt(1)
    v_mfma_f32_16x16x32_bf16 v[92:95], v[200:203], v[12:15], v[92:95]
    ds_read_b128 v[8:11], v0 offset:37120
    v_mfma_f32_16x16x32_bf16 v[96:99], v[204:207], v[12:15], v[96:99]
    v_mfma_f32_16x16x32_bf16 v[100:103], v[208:211], v[12:15], v[100:103]
    v_mfma_f32_16x16x32_bf16 v[104:107], v[212:215], v[12:15], v[104:107]
    v_mfma_f32_16x16x32_bf16 v[108:111], v[216:219], v[12:15], v[108:111]
    s_add_u32 s46, s38, 14336
    v_mfma_f32_16x16x32_bf16 v[112:115], v[220:223], v[12:15], v[112:115]
    buffer_store_dwordx4 v[64:67], v20, s[28:31], s46 offen offset:0 sc1
    v_mfma_f32_16x16x32_bf16 v[116:119], v[224:227], v[12:15], v[116:119]
    s_waitcnt lgkmcnt(0)
    v_mfma_f32_16x16x32_bf16 v[92:95], a[0:3], v[8:11], v[92:95]
    ds_read_b128 v[12:15], v0 offset:33792
    v_mfma_f32_16x16x32_bf16 v[96:99], a[4:7], v[8:11], v[96:99]
    v_mfma_f32_16x16x32_bf16 v[100:103], a[8:11], v[8:11], v[100:103]
    v_mfma_f32_16x16x32_bf16 v[104:107], a[12:15], v[8:11], v[104:107]
    v_mfma_f32_16x16x32_bf16 v[108:111], a[16:19], v[8:11], v[108:111]
    v_mfma_f32_16x16x32_bf16 v[112:115], a[20:23], v[8:11], v[112:115]
    v_mfma_f32_16x16x32_bf16 v[116:119], a[24:27], v[8:11], v[116:119]
    s_waitcnt lgkmcnt(0)
    v_mfma_f32_16x16x32_bf16 v[92:95], v[228:231], v[12:15], v[92:95]
    ds_read_b128 v[8:11], v0 offset:37632
    v_mfma_f32_16x16x32_bf16 v[96:99], v[232:235], v[12:15], v[96:99]
    s_nop 0
    v_mfma_f32_16x16x32_bf16 v[100:103], v[236:239], v[12:15], v[100:103]
    s_nop 0
    v_mfma_f32_16x16x32_bf16 v[104:107], v[240:243], v[12:15], v[104:107]
    s_nop 1
    v_mfma_f32_16x16x32_bf16 v[108:111], v[244:247], v[12:15], v[108:111]
    v_cvt_pk_bf16_f32 v68, v92, v93
    v_cvt_pk_bf16_f32 v69, v94, v95
    v_mfma_f32_16x16x32_bf16 v[112:115], v[248:251], v[12:15], v[112:115]
    v_cvt_pk_bf16_f32 v70, v96, v97
    v_cvt_pk_bf16_f32 v71, v98, v99
    v_mfma_f32_16x16x32_bf16 v[116:119], v[252:255], v[12:15], v[116:119]
    s_waitcnt lgkmcnt(0)
    v_cvt_pk_bf16_f32 v76, v100, v101
    v_cvt_pk_bf16_f32 v77, v102, v103
    v_mfma_f32_16x16x32_bf16 v[92:95], a[28:31], v[8:11], 0
    ds_read_b128 v[12:15], v0 offset:37888
    v_mfma_f32_16x16x32_bf16 v[96:99], a[32:35], v[8:11], 0
    v_cvt_pk_bf16_f32 v78, v104, v105
    v_cvt_pk_bf16_f32 v79, v106, v107
    v_mfma_f32_16x16x32_bf16 v[100:103], a[36:39], v[8:11], 0
    v_cvt_pk_bf16_f32 v84, v108, v109
    v_cvt_pk_bf16_f32 v85, v110, v111
    v_mfma_f32_16x16x32_bf16 v[104:107], a[40:43], v[8:11], 0
    v_cvt_pk_bf16_f32 v86, v112, v113
    v_cvt_pk_bf16_f32 v87, v114, v115
    v_mfma_f32_16x16x32_bf16 v[108:111], a[44:47], v[8:11], 0
    v_cvt_pk_bf16_f32 v18, v116, v117
    v_cvt_pk_bf16_f32 v19, v118, v119
    v_mfma_f32_16x16x32_bf16 v[112:115], a[48:51], v[8:11], 0
    v_mfma_f32_16x16x32_bf16 v[116:119], a[52:55], v[8:11], 0
    s_waitcnt lgkmcnt(0)
    v_mfma_f32_16x16x32_bf16 v[92:95], a[56:59], v[12:15], v[92:95]
    ds_read_b128 v[8:11], v0 offset:38144
    v_mfma_f32_16x16x32_bf16 v[96:99], a[60:63], v[12:15], v[96:99]
    ds_write_b64 v22, v[18:19] offset:13312
    v_mfma_f32_16x16x32_bf16 v[100:103], a[64:67], v[12:15], v[100:103]
    s_add_u32 s46, s38, 14336
    v_mfma_f32_16x16x32_bf16 v[104:107], a[68:71], v[12:15], v[104:107]
    buffer_store_dwordx4 v[72:75], v20, s[28:31], s46 offen offset:64 sc1
    v_mfma_f32_16x16x32_bf16 v[108:111], a[72:75], v[12:15], v[108:111]
    v_mfma_f32_16x16x32_bf16 v[112:115], a[76:79], v[12:15], v[112:115]
    v_mfma_f32_16x16x32_bf16 v[116:119], a[80:83], v[12:15], v[116:119]
    s_waitcnt lgkmcnt(1)
    v_mfma_f32_16x16x32_bf16 v[92:95], a[84:87], v[8:11], v[92:95]
    ds_read_b128 v[12:15], v0 offset:38400
    v_mfma_f32_16x16x32_bf16 v[96:99], a[88:91], v[8:11], v[96:99]
    v_mfma_f32_16x16x32_bf16 v[100:103], a[92:95], v[8:11], v[100:103]
    v_mfma_f32_16x16x32_bf16 v[104:107], a[96:99], v[8:11], v[104:107]
    v_mfma_f32_16x16x32_bf16 v[108:111], a[100:103], v[8:11], v[108:111]
    v_mfma_f32_16x16x32_bf16 v[112:115], a[104:107], v[8:11], v[112:115]
    v_mfma_f32_16x16x32_bf16 v[116:119], a[108:111], v[8:11], v[116:119]
    s_waitcnt lgkmcnt(0)
    v_mfma_f32_16x16x32_bf16 v[92:95], a[112:115], v[12:15], v[92:95]
    ds_read_b128 v[8:11], v0 offset:38656
    v_mfma_f32_16x16x32_bf16 v[96:99], a[116:119], v[12:15], v[96:99]
    s_add_u32 s46, s38, 14336
    v_mfma_f32_16x16x32_bf16 v[100:103], a[120:123], v[12:15], v[100:103]
    buffer_store_dwordx4 v[80:83], v20, s[28:31], s46 offen offset:128 sc1
    v_mfma_f32_16x16x32_bf16 v[104:107], a[124:127], v[12:15], v[104:107]
    v_mfma_f32_16x16x32_bf16 v[108:111], a[128:131], v[12:15], v[108:111]
    v_mfma_f32_16x16x32_bf16 v[112:115], a[132:135], v[12:15], v[112:115]
    v_mfma_f32_16x16x32_bf16 v[116:119], a[136:139], v[12:15], v[116:119]
    ds_read_b128 v[60:63], v16 offset:11776
    s_waitcnt lgkmcnt(1)
    v_mfma_f32_16x16x32_bf16 v[92:95], a[140:143], v[8:11], v[92:95]
    ds_read_b128 v[12:15], v0 offset:38912
    v_mfma_f32_16x16x32_bf16 v[96:99], a[144:147], v[8:11], v[96:99]
    v_mfma_f32_16x16x32_bf16 v[100:103], a[148:151], v[8:11], v[100:103]
    v_mfma_f32_16x16x32_bf16 v[104:107], a[152:155], v[8:11], v[104:107]
    v_mfma_f32_16x16x32_bf16 v[108:111], a[156:159], v[8:11], v[108:111]
    v_mfma_f32_16x16x32_bf16 v[112:115], a[160:163], v[8:11], v[112:115]
    v_mfma_f32_16x16x32_bf16 v[116:119], a[164:167], v[8:11], v[116:119]
L_pad3:
    s_cbranch_vccnz L_padret0
    s_add_u32 s46, s47, 7168
    s_add_u32 s46, s46, s38
    s_waitcnt lgkmcnt(0)
    v_mfma_f32_16x16x32_bf16 v[92:95], a[168:171], v[12:15], v[92:95]
    s_waitcnt lgkmcnt(1)
    ds_read_b128 v[8:11], v0 offset:39168
    v_mfma_f32_16x16x32_bf16 v[96:99], a[172:175], v[12:15], v[96:99]
    buffer_store_dwordx4 v[60:63], v21, s[28:31], s46 offen sc1
    v_mfma_f32_16x16x32_bf16 v[100:103], a[176:179], v[12:15], v[100:103]
    v_mfma_f32_16x16x32_bf16 v[104:107], a[180:183], v[12:15], v[104:107]
    v_mfma_f32_16x16x32_bf16 v[108:111], a[184:187], v[12:15], v[108:111]
    v_mfma_f32_16x16x32_bf16 v[112:115], a[188:191], v[12:15], v[112:115]
    v_mfma_f32_16x16x32_bf16 v[116:119], a[192:195], v[12:15], v[116:119]
    s_waitcnt lgkmcnt(0)
    v_mfma_f32_16x16x32_bf16 v[92:95], a[196:199], v[8:11], v[92:95]
    ds_read_b128 v[12:15], v0 offset:39424
    v_mfma_f32_16x16x32_bf16 v[96:99], a[200:203], v[8:11], v[96:99]
    v_mfma_f32_16x16x32_bf16 v[100:103], a[204:207], v[8:11], v[100:103]
    v_mfma_f32_16x16x32_bf16 v[104:107], a[208:211], v[8:11], v[104:107]
    v_mfma_f32_16x16x32_bf16 v[108:111], a[212:215], v[8:11], v[108:111]
    v_mfma_f32_16x16x32_bf16 v[112:115], a[216:219], v[8:11], v[112:115]
    v_mfma_f32_16x16x32_bf16 v[116:119], a[220:223], v[8:11], v[116:119]
    s_waitcnt lgkmcnt(0)
    v_mfma_f32_16x16x32_bf16 v[92:95], a[224:227], v[12:15], v[92:95]
    s_add_u32 s46, s38, 17920
    ds_read_b128 v[8:11], v0 offset:39680
    v_mfma_f32_16x16x32_bf16 v[96:99], a[228:231], v[12:15], v[96:99]
    buffer_store_dwordx4 v[68:71], v20, s[28:31], s46 offen offset:0 sc1
    v_mfma_f32_16x16x32_bf16 v[100:103], a[232:235], v[12:15], v[100:103]
    v_mfma_f32_16x16x32_bf16 v[104:107], a[236:239], v[12:15], v[104:107]
    v_mfma_f32_16x16x32_bf16 v[108:111], a[240:243], v[12:15], v[108:111]
    v_mfma_f32_16x16x32_bf16 v[112:115], a[244:247], v[12:15], v[112:115]
    v_mfma_f32_16x16x32_bf16 v[116:119], a[248:251], v[12:15], v[116:119]
    s_waitcnt lgkmcnt(0)
    v_mfma_f32_16x16x32_bf16 v[92:95], a[252:255], v[8:11], v[92:95]
    ds_read_b128 v[12:15], v0 offset:39936
    v_mfma_f32_16x16x32_bf16 v[96:99], v[120:123], v[8:11], v[96:99]
    v_mfma_f32_16x16x32_bf16 v[100:103], v[124:127], v[8:11], v[100:103]
    v_mfma_f32_16x16x32_bf16 v[104:107], v[128:131], v[8:11], v[104:107]
    v_mfma_f32_16x16x32_bf16 v[108:111], v[132:135], v[8:11], v[108:111]
    v_mfma_f32_16x16x32_bf16 v[112:115], v[136:139], v[8:11], v[112:115]
    v_mfma_f32_16x16x32_bf16 v[116:119], v[140:143], v[8:11], v[116:119]
    s_waitcnt lgkmcnt(0)
    v_mfma_f32_16x16x32_bf16 v[92:95], v[144:147], v[12:15], v[92:95]
    s_add_u32 s46, s38, 17920
    ds_read_b128 v[8:11], v0 offset:40192
    v_mfma_f32_16x16x32_bf16 v[96:99], v[148:151], v[12:15], v[96:99]
    buffer_store_dwordx4 v[76:79], v20, s[28:31], s46 offen offset:64 sc1
    v_mfma_f32_16x16x32_bf16 v[100:103], v[152:155], v[12:15], v[100:103]
    v_mfma_f32_16x16x32_bf16 v[104:107], v[156:159], v[12:15], v[104:107]
    v_mfma_f32_16x16x32_bf16 v[108:111], v[160:163], v[12:15], v[108:111]
    v_mfma_f32_16x16x32_bf16 v[112:115], v[164:167], v[12:15], v[112:115]
    v_mfma_f32_16x16x32_bf16 v[116:119], v[168:171], v[12:15], v[116:119]
    s_waitcnt lgkmcnt(0)
    v_mfma_f32_16x16x32_bf16 v[92:95], v[172:175], v[8:11], v[92:95]
    ds_read_b128 v[12:15], v0 offset:40448
    v_mfma_f32_16x16x32_bf16 v[96:99], v[176:179], v[8:11], v[96:99]
    v_mfma_f32_16x16x32_bf16 v[100:103], v[180:183], v[8:11], v[100:103]
    v_mfma_f32_16x16x32_bf16 v[104:107], v[184:187], v[8:11], v[104:107]
    v_mfma_f32_16x16x32_bf16 v[108:111], v[188:191], v[8:11], v[108:111]
    v_mfma_f32_16x16x32_bf16 v[112:115], v[192:195], v[8:11], v[112:115]
    v_mfma_f32_16x16x32_bf16 v[116:119], v[196:199], v[8:11], v[116:119]
    s_waitcnt lgkmcnt(0)
    v_mfma_f32_16x16x32_bf16 v[92:95], v[200:203], v[12:15], v[92:95]
    s_add_u32 s46, s38, 17920
    ds_read_b128 v[8:11], v0 offset:40704
    v_mfma_f32_16x16x32_bf16 v[96:99], v[204:207], v[12:15], v[96:99]
    buffer_store_dwordx4 v[84:87], v20, s[28:31], s46 offen offset:128 sc1
    v_mfma_f32_16x16x32_bf16 v[100:103], v[208:211], v[12:15], v[100:103]
    v_mfma_f32_16x16x32_bf16 v[104:107], v[212:215], v[12:15], v[104:107]
    v_mfma_f32_16x16x32_bf16 v[108:111], v[216:219], v[12:15], v[108:111]
    v_mfma_f32_16x16x32_bf16 v[112:115], v[220:223], v[12:15], v[112:115]
    v_mfma_f32_16x16x32_bf16 v[116:119], v[224:227], v[12:15], v[116:119]
    s_waitcnt lgkmcnt(0)
    v_mfma_f32_16x16x32_bf16 v[92:95], a[0:3], v[8:11], v[92:95]
    ds_read_b128 v[12:15], v0 offset:37376
    v_mfma_f32_16x16x32_bf16 v[96:99], a[4:7], v[8:11], v[96:99]
    v_mfma_f32_16x16x32_bf16 v[100:103], a[8:11], v[8:11], v[100:103]
    v_mfma_f32_16x16x32_bf16 v[104:107], a[12:15], v[8:11], v[104:107]
    v_mfma_f32_16x16x32_bf16 v[108:111], a[16:19], v[8:11], v[108:111]
    v_mfma_f32_16x16x32_bf16 v[112:115], a[20:23], v[8:11], v[112:115]
    v_mfma_f32_16x16x32_bf16 v[116:119], a[24:27], v[8:11], v[116:119]
    s_waitcnt lgkmcnt(0)
    v_mfma_f32_16x16x32_bf16 v[92:95], v[228:231], v[12:15], v[92:95]
    s_barrier
    ds_read_b128 v[8:11], v0 offset:7424
    v_mfma_f32_16x16x32_bf16 v[96:99], v[232:235], v[12:15], v[96:99]
    s_nop 0
    v_mfma_f32_16x16x32_bf16 v[100:103], v[236:239], v[12:15], v[100:103]
    s_nop 0
    v_mfma_f32_16x16x32_bf16 v[104:107], v[240:243], v[12:15], v[104:107]
    s_nop 1
    v_mfma_f32_16x16x32_bf16 v[108:111], v[244:247], v[12:15], v[108:111]
    v_cvt_pk_bf16_f32 v40, v92, v93
    v_cvt_pk_bf16_f32 v41, v94, v95
    v_mfma_f32_16x16x32_bf16 v[112:115], v[248:251], v[12:15], v[112:115]
    v_cvt_pk_bf16_f32 v42, v96, v97
    v_cvt_pk_bf16_f32 v43, v98, v99
    v_mfma_f32_16x16x32_bf16 v[116:119], v[252:255], v[12:15], v[116:119]
    s_waitcnt lgkmcnt(0)
    v_cvt_pk_bf16_f32 v48, v100, v101
    v_cvt_pk_bf16_f32 v49, v102, v103
    v_mfma_f32_16x16x32_bf16 v[92:95], a[28:31], v[8:11], 0
    ds_read_b128 v[12:15], v0 offset:7680
    v_mfma_f32_16x16x32_bf16 v[96:99], a[32:35], v[8:11], 0
    v_cvt_pk_bf16_f32 v50, v104, v105
    v_cvt_pk_bf16_f32 v51, v106, v107
    v_mfma_f32_16x16x32_bf16 v[100:103], a[36:39], v[8:11], 0
    v_cvt_pk_bf16_f32 v56, v108, v109
    v_cvt_pk_bf16_f32 v57, v110, v111
    v_mfma_f32_16x16x32_bf16 v[104:107], a[40:43], v[8:11], 0
    v_cvt_pk_bf16_f32 v58, v112, v113
    v_cvt_pk_bf16_f32 v59, v114, v115
    v_mfma_f32_16x16x32_bf16 v[108:111], a[44:47], v[8:11], 0
    v_cvt_pk_bf16_f32 v18, v116, v117
    v_cvt_pk_bf16_f32 v19, v118, v119
    v_mfma_f32_16x16x32_bf16 v[112:115], a[48:51], v[8:11], 0
    v_mfma_f32_16x16x32_bf16 v[116:119], a[52:55], v[8:11], 0
    s_waitcnt lgkmcnt(0)
    v_mfma_f32_16x16x32_bf16 v[92:95], a[56:59], v[12:15], v[92:95]
    ds_read_b128 v[8:11], v0 offset:7936
    v_mfma_f32_16x16x32_bf16 v[96:99], a[60:63], v[12:15], v[96:99]
    ds_write_b64 v22, v[18:19] offset:13824
    v_mfma_f32_16x16x32_bf16 v[100:103], a[64:67], v[12:15], v[100:103]
    s_add_u32 s46, s38, 21504
    v_mfma_f32_16x16x32_bf16 v[104:107], a[68:71], v[12:15], v[104:107]
    buffer_store_dwordx4 v[40:43], v20, s[28:31], s46 offen offset:0 sc1
    v_mfma_f32_16x16x32_bf16 v[108:111], a[72:75], v[12:15], v[108:111]
    v_mfma_f32_16x16x32_bf16 v[112:115], a[76:79], v[12:15], v[112:115]
    v_mfma_f32_16x16x32_bf16 v[116:119], a[80:83], v[12:15], v[116:119]
    s_waitcnt lgkmcnt(1)
    v_mfma_f32_16x16x32_bf16 v[92:95], a[84:87], v[8:11], v[92:95]
    ds_read_b128 v[12:15], v0 offset:8192
    v_mfma_f32_16x16x32_bf16 v[96:99], a[88:91], v[8:11], v[96:99]
    v_mfma_f32_16x16x32_bf16 v[100:103], a[92:95], v[8:11], v[100:103]
    v_mfma_f32_16x16x32_bf16 v[104:107], a[96:99], v[8:11], v[104:107]
    v_mfma_f32_16x16x32_bf16 v[108:111], a[100:103], v[8:11], v[108:111]
    s_add_u32 s46, s38, 21504
    v_mfma_f32_16x16x32_bf16 v[112:115], a[104:107], v[8:11], v[112:115]
    buffer_store_dwordx4 v[48:51], v20, s[28:31], s46 offen offset:64 sc1
    v_mfma_f32_16x16x32_bf16 v[116:119], a[108:111], v[8:11], v[116:119]
    ds_read_b128 v[60:63], v16 offset:12800
    s_waitcnt lgkmcnt(1)
    v_mfma_f32_16x16x32_bf16 v[92:95], a[112:115], v[12:15], v[92:95]
    ds_read_b128 v[8:11], v0 offset:8448
    v_mfma_f32_16x16x32_bf16 v[96:99], a[116:119], v[12:15], v[96:99]
    ds_read_b128 v[24:27], v0 offset:8960
    v_mfma_f32_16x16x32_bf16 v[100:103], a[120:123], v[12:15], v[100:103]
    ds_read_b128 v[28:31], v0 offset:9216
    v_mfma_f32_16x16x32_bf16 v[104:107], a[124:127], v[12:15], v[104:107]
    ds_read_b128 v[32:35], v0 offset:9472
    v_mfma_f32_16x16x32_bf16 v[108:111], a[128:131], v[12:15], v[108:111]
    ds_read_b128 v[88:91], v0 offset:9728
    v_mfma_f32_16x16x32_bf16 v[112:115], a[132:135], v[12:15], v[112:115]
    ds_read_b128 v[64:67], v0 offset:9984
    v_mfma_f32_16x16x32_bf16 v[116:119], a[136:139], v[12:15], v[116:119]
    s_add_u32 s46, s47, 14336
    s_add_u32 s46, s46, s38
    s_waitcnt lgkmcnt(5)
    v_mfma_f32_16x16x32_bf16 v[92:95], a[140:143], v[8:11], v[92:95]
    s_waitcnt lgkmcnt(6)
    ds_read_b128 v[12:15], v0 offset:8704
    v_mfma_f32_16x16x32_bf16 v[96:99], a[144:147], v[8:11], v[96:99]
    buffer_store_dwordx4 v[60:63], v21, s[28:31], s46 offen sc1
    v_mfma_f32_16x16x32_bf16 v[100:103], a[148:151], v[8:11], v[100:103]
    ds_read_b128 v[72:75], v0 offset:10240
    v_mfma_f32_16x16x32_bf16 v[104:107], a[152:155], v[8:11], v[104:107]
    ds_read_b128 v[80:83], v0 offset:10496
    v_mfma_f32_16x16x32_bf16 v[108:111], a[156:159], v[8:11], v[108:111]
    ds_read_b128 v[68:71], v0 offset:7168
    v_mfma_f32_16x16x32_bf16 v[112:115], a[160:163], v[8:11], v[112:115]
    v_mfma_f32_16x16x32_bf16 v[116:119], a[164:167], v[8:11], v[116:119]
    s_waitcnt lgkmcnt(3)
    v_mfma_f32_16x16x32_bf16 v[92:95], a[168:171], v[12:15], v[92:95]
    v_mfma_f32_16x16x32_bf16 v[96:99], a[172:175], v[12:15], v[96:99]
    s_add_u32 s46, s38, 21504
    v_mfma_f32_16x16x32_bf16 v[100:103], a[176:179], v[12:15], v[100:103]
    buffer_store_dwordx4 v[56:59], v20, s[28:31], s46 offen offset:128 sc1
    v_mfma_f32_16x16x32_bf16 v[104:107], a[180:183], v[12:15], v[104:107]
    v_mfma_f32_16x16x32_bf16 v[108:111], a[184:187], v[12:15], v[108:111]
    v_mfma_f32_16x16x32_bf16 v[112:115], a[188:191], v[12:15], v[112:115]
    v_mfma_f32_16x16x32_bf16 v[116:119], a[192:195], v[12:15], v[116:119]
    s_waitcnt lgkmcnt(0)
    v_mfma_f32_16x16x32_bf16 v[116:119], a[220:223], v[24:27], v[116:119]
    v_mfma_f32_16x16x32_bf16 v[116:119], a[248:251], v[28:31], v[116:119]
    v_mfma_f32_16x16x32_bf16 v[116:119], v[140:143], v[32:35], v[116:119]
    v_mfma_f32_16x16x32_bf16 v[116:119], v[168:171], v[88:91], v[116:119]
    v_mfma_f32_16x16x32_bf16 v[116:119], v[196:199], v[64:67], v[116:119]
    v_mfma_f32_16x16x32_bf16 v[116:119], v[224:227], v[72:75], v[116:119]
    v_mfma_f32_16x16x32_bf16 v[116:119], a[24:27], v[80:83], v[116:119]
    v_mfma_f32_16x16x32_bf16 v[116:119], v[252:255], v[68:71], v[116:119]
    v_mfma_f32_16x16x32_bf16 v[92:95], a[196:199], v[24:27], v[92:95]
    s_nop 1
    v_mfma_f32_16x16x32_bf16 v[96:99], a[200:203], v[24:27], v[96:99]
    s_nop 1
    v_mfma_f32_16x16x32_bf16 v[92:95], a[224:227], v[28:31], v[92:95]
    s_nop 0
    v_cvt_pk_bf16_f32 v18, v116, v117
    v_cvt_pk_bf16_f32 v19, v118, v119
    v_mfma_f32_16x16x32_bf16 v[96:99], a[228:231], v[28:31], v[96:99]
    ds_write_b64 v22, v[18:19] offset:14336
    v_mfma_f32_16x16x32_bf16 v[92:95], a[252:255], v[32:35], v[92:95]
    v_mfma_f32_16x16x32_bf16 v[96:99], v[120:123], v[32:35], v[96:99]
    v_mfma_f32_16x16x32_bf16 v[92:95], v[144:147], v[88:91], v[92:95]
    s_waitcnt lgkmcnt(0)
    s_barrier
    v_mfma_f32_16x16x32_bf16 v[96:99], v[148:151], v[88:91], v[96:99]
    ds_read_b128 v[60:63], v16 offset:13824
    v_mfma_f32_16x16x32_bf16 v[92:95], v[172:175], v[64:67], v[92:95]
    v_mfma_f32_16x16x32_bf16 v[96:99], v[176:179], v[64:67], v[96:99]
    v_mfma_f32_16x16x32_bf16 v[92:95], v[200:203], v[72:75], v[92:95]
    v_mfma_f32_16x16x32_bf16 v[96:99], v[204:207], v[72:75], v[96:99]
    v_mfma_f32_16x16x32_bf16 v[92:95], a[0:3], v[80:83], v[92:95]
    v_mfma_f32_16x16x32_bf16 v[96:99], a[4:7], v[80:83], v[96:99]
    s_add_u32 s46, s47, 21504
    s_add_u32 s46, s46, s38
    v_mfma_f32_16x16x32_bf16 v[92:95], v[228:231], v[68:71], v[92:95]
    s_waitcnt lgkmcnt(0)
    v_mfma_f32_16x16x32_bf16 v[96:99], v[232:235], v[68:71], v[96:99]
    buffer_store_dwordx4 v[60:63], v21, s[28:31], s46 offen sc1
    v_mfma_f32_16x16x32_bf16 v[100:103], a[204:207], v[24:27], v[100:103]
    s_nop 1
    v_mfma_f32_16x16x32_bf16 v[104:107], a[208:211], v[24:27], v[104:107]
    s_nop 1
    v_mfma_f32_16x16x32_bf16 v[100:103], a[232:235], v[28:31], v[100:103]
    s_nop 0
    v_cvt_pk_bf16_f32 v36, v92, v93
    v_cvt_pk_bf16_f32 v37, v94, v95
    v_mfma_f32_16x16x32_bf16 v[104:107], a[236:239], v[28:31], v[104:107]
    s_add_u32 s46, s38, 25088
    v_cvt_pk_bf16_f32 v38, v96, v97
    v_cvt_pk_bf16_f32 v39, v98, v99
    v_mfma_f32_16x16x32_bf16 v[100:103], v[124:127], v[32:35], v[100:103]
    buffer_store_dwordx4 v[36:39], v20, s[28:31], s46 offen offset:0 sc1
    v_mfma_f32_16x16x32_bf16 v[104:107], v[128:131], v[32:35], v[104:107]
    v_mfma_f32_16x16x32_bf16 v[100:103], v[152:155], v[88:91], v[100:103]
    v_mfma_f32_16x16x32_bf16 v[104:107], v[156:159], v[88:91], v[104:107]
    v_mfma_f32_16x16x32_bf16 v[100:103], v[180:183], v[64:67], v[100:103]
    v_mfma_f32_16x16x32_bf16 v[104:107], v[184:187], v[64:67], v[104:107]
    v_mfma_f32_16x16x32_bf16 v[100:103], v[208:211], v[72:75], v[100:103]
    v_mfma_f32_16x16x32_bf16 v[104:107], v[212:215], v[72:75], v[104:107]
    v_mfma_f32_16x16x32_bf16 v[100:103], a[8:11], v[80:83], v[100:103]
    v_mfma_f32_16x16x32_bf16 v[104:107], a[12:15], v[80:83], v[104:107]
    v_mfma_f32_16x16x32_bf16 v[100:103], v[236:239], v[68:71], v[100:103]
    v_mfma_f32_16x16x32_bf16 v[104:107], v[240:243], v[68:71], v[104:107]
    v_mfma_f32_16x16x32_bf16 v[108:111], a[212:215], v[24:27], v[108:111]
    s_nop 1
    v_mfma_f32_16x16x32_bf16 v[112:115], a[216:219], v[24:27], v[112:115]
    s_nop 1
    v_mfma_f32_16x16x32_bf16 v[108:111], a[240:243], v[28:31], v[108:111]
    s_nop 0
    v_cvt_pk_bf16_f32 v44, v100, v101
    v_cvt_pk_bf16_f32 v45, v102, v103
    v_mfma_f32_16x16x32_bf16 v[112:115], a[244:247], v[28:31], v[112:115]
    s_add_u32 s46, s38, 25088
    v_cvt_pk_bf16_f32 v46, v104, v105
    v_cvt_pk_bf16_f32 v47, v106, v107
    v_mfma_f32_16x16x32_bf16 v[108:111], v[132:135], v[32:35], v[108:111]
    buffer_store_dwordx4 v[44:47], v20, s[28:31], s46 offen offset:64 sc1
    v_mfma_f32_16x16x32_bf16 v[112:115], v[136:139], v[32:35], v[112:115]
    v_mfma_f32_16x16x32_bf16 v[108:111], v[160:163], v[88:91], v[108:111]
    v_mfma_f32_16x16x32_bf16 v[112:115], v[164:167], v[88:91], v[112:115]
    v_mfma_f32_16x16x32_bf16 v[108:111], v[188:191], v[64:67], v[108:111]
    v_mfma_f32_16x16x32_bf16 v[112:115], v[192:195], v[64:67], v[112:115]
    v_mfma_f32_16x16x32_bf16 v[108:111], v[216:219], v[72:75], v[108:111]
    v_mfma_f32_16x16x32_bf16 v[112:115], v[220:223], v[72:75], v[112:115]
    v_mfma_f32_16x16x32_bf16 v[108:111], a[16:19], v[80:83], v[108:111]
    v_mfma_f32_16x16x32_bf16 v[112:115], a[20:23], v[80:83], v[112:115]
    v_mfma_f32_16x16x32_bf16 v[108:111], v[244:247], v[68:71], v[108:111]
    v_mfma_f32_16x16x32_bf16 v[112:115], v[248:251], v[68:71], v[112:115]
    s_nop 6
    v_cvt_pk_bf16_f32 v52, v108, v109
    v_cvt_pk_bf16_f32 v53, v110, v111
    v_cvt_pk_bf16_f32 v54, v112, v113
    v_cvt_pk_bf16_f32 v55, v114, v115
    buffer_store_dwordx4 v[52:55], v20, s[28:31], s46 offen offset:128 sc1
L_end:
    s_endpgm
.fill 3000, 4, 0xbf810000
.section .rodata,"a"
.p2align 6
.amdhsa_kernel standalone__layernorm_linear__sampling_kernel
  .amdhsa_next_free_vgpr 512
  .amdhsa_next_free_sgpr 102
  .amdhsa_accum_offset 256
  .amdhsa_group_segment_fixed_size 0
  .amdhsa_kernarg_size 56
  .amdhsa_user_sgpr_count 2
  .amdhsa_user_sgpr_kernarg_segment_ptr 1
  .amdhsa_system_sgpr_workgroup_id_x 1
.end_amdhsa_kernel
```
